```python
import torch

def _softmax(x, axis=-1):
    return torch.softmax(x, dim=axis)
def _gelu(x):
    return torch.nn.functional.gelu(x, approximate="tanh")
def _silu(x):
    return torch.nn.functional.silu(x)
def _sigmoid(x):
    return torch.sigmoid(x)
def _layernorm(x, axis=-1, eps=1e-5):
    m = x.mean(dim=axis, keepdim=True)
    v = x.var(dim=axis, keepdim=True, unbiased=False)
    return (x - m) / torch.sqrt(v + eps)
def _scatter_add(tgt, idx, src, axis=0):
    return tgt.clone().index_add_(axis, idx, src)
def _segment_sum(src, seg, n):
    out = torch.zeros((n,) + src.shape[1:], dtype=src.dtype)
    return out.index_add_(0, seg, src)
def _pad(x, pw):
    flat = tuple(v for pair in reversed(pw) for v in pair)
    return torch.nn.functional.pad(x, flat)

kernel_name = 'gated_mix__ssm_conv_s4__geglu_ffn__prompt'

def setup_inputs():

    _w = (lambda a: (lambda t: t.to(torch.bfloat16) if t.is_floating_point() else t)(torch.as_tensor(a)))
    def _A_setup():
        B, L, D, N = 1, 2048, 448, 256
        A_re = -(lambda _x: torch.exp(torch.as_tensor(_x)))((lambda *s: torch.randn(*s, dtype=torch.bfloat16) * 3.2)(D, N))
        A_im = torch.pi * (lambda *s: torch.randn(*s, dtype=torch.bfloat16) * 0.05)(D, N)
        B_re = (lambda *s: torch.randn(*s, dtype=torch.bfloat16) * 0.05)(D, N)
        B_im = (lambda *s: torch.randn(*s, dtype=torch.bfloat16) * 0.05)(D, N)
        C_re = (lambda *s: torch.randn(*s, dtype=torch.bfloat16) * 0.1)(D, N)
        C_im = (lambda *s: torch.randn(*s, dtype=torch.bfloat16) * 0.1)(D, N)
        log_dt = (lambda *s: torch.randn(*s, dtype=torch.bfloat16) * 0.05)(D) * 0.5 - 4.0
        Dskip = (lambda *s: torch.randn(*s, dtype=torch.bfloat16) * 0.05)(D)
        return {
            "u": _w((lambda *s: torch.randn(*s, dtype=torch.bfloat16) * 0.05)(B, L, D)),
            "A_re": _w(A_re),
            "A_im": _w(A_im),
            "B_re": _w(B_re),
            "B_im": _w(B_im),
            "C_re": _w(C_re),
            "C_im": _w(C_im),
            "log_dt": _w(log_dt),
            "Dskip": _w(Dskip),
        }
    _A_in = _A_setup()

    def _B_setup():
        B, S, D, F = 1, 2048, 448, 1792
        return {
            "x": _w((lambda *s: torch.randn(*s, dtype=torch.bfloat16) * 0.05)(B, S, D)),
            "w_gate": _w((lambda *s: torch.randn(*s, dtype=torch.bfloat16) * 0.05)(D, F)),
            "w_up": _w((lambda *s: torch.randn(*s, dtype=torch.bfloat16) * 0.05)(D, F)),
            "w_down": _w((lambda *s: torch.randn(*s, dtype=torch.bfloat16) * 0.05)(F, D)),
        }
    _B_in = _B_setup()

    return {
        "A_u": _A_in["u"],
        "A_A_re": _A_in["A_re"],
        "A_A_im": _A_in["A_im"],
        "A_B_re": _A_in["B_re"],
        "A_B_im": _A_in["B_im"],
        "A_C_re": _A_in["C_re"],
        "A_C_im": _A_in["C_im"],
        "A_log_dt": _A_in["log_dt"],
        "A_Dskip": _A_in["Dskip"],
        "B_x": _B_in["x"],
        "B_w_gate": _B_in["w_gate"],
        "B_w_up": _B_in["w_up"],
        "B_w_down": _B_in["w_down"],
        "gate_w": _w((lambda *s: torch.randn(*s, dtype=torch.bfloat16) * 0.05)(448) * 16.0),
    }

def reference(A_u, A_A_re, A_A_im, A_B_re, A_B_im, A_C_re, A_C_im, A_log_dt, A_Dskip, B_x, B_w_gate, B_w_up, B_w_down, gate_w):
    def _A_ref(u, A_re, A_im, B_re, B_im, C_re, C_im, log_dt, Dskip):
        Bsz, L, D = u.shape
        dt = torch.exp(log_dt)[:, None]
        A = A_re + 1j * A_im
        Bc = B_re + 1j * B_im
        Cc = C_re + 1j * C_im
        logdA = dt * A
        dB = dt * Bc
        l = (lambda x, dt: x.to(dt))(torch.arange(L), A_re.dtype)
        P = torch.exp(logdA[:, :, None] * l[None, None, :])
        K = torch.einsum("dn,dnl,dn->dl", Cc, P, dB).real
        L2 = 2 * L
        Kp = _pad(K, ((0, 0), (0, L)))
        up = (lambda x, *d: x.permute(*d))(u, 0, 2, 1)
        up = _pad(up, ((0, 0), (0, 0), (0, L)))
        Kf = (lambda x, axes=(-2,-1): torch.fft.rfft2(x.float(), dim=axes))(Kp[:, None, :], axes=(-2, -1))
        Uf = (lambda x, axes=(-2,-1): torch.fft.rfft2(x.float(), dim=axes))(up[:, :, None, :], axes=(-2, -1))
        Yf = Uf * Kf[None, :, :, :]
        y = (lambda x, s, axes=(-2,-1): torch.fft.irfft2(x, s=s, dim=axes).to(torch.bfloat16))(Yf, (1, L2), axes=(-2, -1))[:, :, 0, :L]
        y = (lambda x, *d: x.permute(*d))(y, 0, 2, 1) + u * Dskip[None, None, :]
        return y

    def _B_ref(x, w_gate, w_up, w_down):
        return (_gelu(x @ w_gate) * (x @ w_up)) @ w_down

    x = A_u
    g = _sigmoid((x * gate_w).sum(-1, keepdims=True))
    a = _A_ref(x, A_A_re, A_A_im, A_B_re, A_B_im, A_C_re, A_C_im, A_log_dt, A_Dskip)
    b = _B_ref(x, B_w_gate, B_w_up, B_w_down)
    return g * a + (1 - g) * b
```

```asm
; @launch grid=(256,1,1) block=(256,1,1) lds=163840
.amdgcn_target "amdgcn-amd-amdhsa--gfx950"
.text
.p2align 12
.globl gated_mix__ssm_conv_s4__geglu_ffn__prompt_kernel
.p2align 8
.type gated_mix__ssm_conv_s4__geglu_ffn__prompt_kernel,@function
gated_mix__ssm_conv_s4__geglu_ffn__prompt_kernel:
    s_load_dwordx16 s[4:19], s[0:1], 0
    s_load_dwordx16 s[20:35], s[0:1], 64
    s_load_dwordx2 s[36:37], s[0:1], 128
    s_cmp_ge_u32 s2, 256
    s_cbranch_scc1 L_end
    s_getpc_b64 s[38:39]
L_pc:
    s_lshr_b32 s3, s2, 3
    v_lshrrev_b32 v2, 4, v0
    v_lshl_add_u32 v2, v2, 5, s3
    v_lshlrev_b32_e64 v2, 7, v2
    v_min_u32 v2, L_end-L_pc, v2
    v_mov_b32 v5, s39
    v_add_co_u32 v4, vcc, s38, v2
    v_and_b32 v1, 63, v0
    v_lshrrev_b32 v2, 6, v0
    v_addc_co_u32 v5, vcc, 0, v5, vcc
    global_load_dword v3, v[4:5], off
    v_readfirstlane_b32 s60, v2
    s_cmp_lt_u32 s2, 32
    s_cbranch_scc1 L_helper
    s_sub_u32 s61, s2, 32
    s_lshl_b32 s68, s61, 10
    v_lshl_add_u32 v172, v0, 2, s68
    s_lshl_b32 s71, s61, 2
    s_waitcnt lgkmcnt(0)
    global_load_dword v16, v172, s[6:7]
    global_load_dword v17, v172, s[8:9]
    global_load_dword v18, v172, s[10:11]
    global_load_dword v19, v172, s[12:13]
    global_load_dword v20, v172, s[14:15]
    global_load_dword v21, v172, s[16:17]
    s_load_dword s72, s[18:19], s71
    s_load_dword s73, s[20:21], s71
    s_lshr_b32 s68, s61, 3
    s_and_b32 s69, s61, 6
    s_lshl_b32 s62, s69, 1
    s_and_b32 s69, s68, 3
    s_add_u32 s62, s62, s69
    s_lshr_b32 s64, s68, 2
    s_and_b32 s65, s61, 7
    s_lshl2_add_u32 s65, s65, s69
    s_bfe_u32 s68, s61, 0x10001
    s_add_u32 s68, s68, s64
    s_lshl1_add_u32 s68, s69, s68
    s_lshl_b32 s68, s68, 7
    s_cmp_ge_u32 s68, 896
    s_cselect_b32 s69, 896, 0
    s_sub_u32 s77, s68, s69
    s_add_u32 s68, s77, 128
    s_cmp_ge_u32 s68, 896
    s_cselect_b32 s69, 896, 0
    s_sub_u32 s78, s68, s69
    s_and_b32 s69, s61, 1
    s_mul_i32 s63, s69, 7
    s_add_u32 s63, s63, s64
    s_lshr_b32 s66, s60, 1
    s_and_b32 s67, s60, 1
    s_lshl_b32 s70, s60, 12
    v_lshrrev_b32 v173, 3, v1
    v_and_b32_e64 v174, 7, v1
    v_lshrrev_b32 v175, 4, v1
    s_lshl2_add_u32 s68, s62, s60
    s_mul_i32 s68, s68, 28672
    v_mul_u32_u24 v176, 896, v173
    v_add_u32 v176, s68, v176
    v_xor_b32 v177, v174, v175
    v_lshl_add_u32 v4, v177, 4, v176
    v_xor_b32_e64 v177, 4, v177
    v_lshl_add_u32 v5, v177, 4, v176
    v_add_u32 v6, 12288, v4
    v_add_u32 v7, 18432, v5
    v_add_u32 v5, 6144, v5
    v_and_b32 v175, 1, v175
    v_lshlrev_b32 v182, 2, v175
    v_xor_b32_e64 v182, v174, v182
    s_mul_i32 s68, s67, 114688
    s_lshl_b32 s69, s63, 7
    s_add_u32 s68, s68, s69
    v_mul_u32_u24 v176, 3584, v173
    v_add_u32_e64 v176, s68, v176
    v_lshl_add_u32 v8, v182, 4, v176
    v_xor_b32_e64 v176, 32, v8
    v_add_u32 v10, 55296, v8
    v_add_u32 v9, 27648, v176
    v_add_u32 v11, 82944, v176
    s_mov_b32 s42, 1835008
    s_mov_b32 s43, 0x20000
    s_mov_b32 s46, 1605632
    s_mov_b32 s47, 0x20000
    s_cmp_eq_u32 s66, 0
    s_cselect_b32 s44, s24, s26
    s_cselect_b32 s45, s25, s27
    s_and_b32 s45, s45, 0xffff
    s_mov_b32 s40, s4
    s_and_b32 s41, s5, 0xffff
    s_add_u32 m0, s70, 49152
    s_mul_i32 s71, s77, 1792
    buffer_load_dwordx4 v8, s[44:47], s71 offen offset:0  lds
    v_mov_b32_e64 v178, 0
    v_min_u32 v176, 239, v0
    v_lshlrev_b32 v176, 2, v176
    v_and_b32 v179, 15, v1
    v_lshlrev_b32_e64 v177, 2, v179
    ds_write_b32 v176, v178 offset:8320
    ds_write_b32 v176, v178 offset:13376
    ds_write_b32 v177, v178 offset:0
    ds_write_b32 v177, v178 offset:4160
    s_add_u32 s68, s78, 128
    s_cmp_ge_u32 s68, 896
    s_cselect_b32 s69, 896, 0
    s_sub_u32 s79, s68, s69
    s_add_u32 s68, s79, 128
    s_cmp_ge_u32 s68, 896
    s_cselect_b32 s69, 896, 0
    s_sub_u32 s80, s68, s69
    buffer_load_dwordx4 v9, s[44:47], s71 offen offset:1024  lds
    s_add_u32 s68, s80, 128
    s_cmp_ge_u32 s68, 896
    s_cselect_b32 s69, 896, 0
    s_sub_u32 s81, s68, s69
    s_add_u32 s68, s81, 128
    s_cmp_ge_u32 s68, 896
    s_cselect_b32 s69, 896, 0
    s_sub_u32 s82, s68, s69
    s_add_u32 s68, s82, 128
    s_cmp_ge_u32 s68, 896
    s_cselect_b32 s69, 896, 0
    s_sub_u32 s83, s68, s69
    v_lshlrev_b32 v2, 4, v1
    v_lshrrev_b32_e64 v180, 5, v1
    s_mul_i32 s74, s60, 8704
    s_add_u32 s74, s74, 14336
    v_and_b32_e64 v178, 31, v1
    v_mul_u32_u24 v176, 272, v178
    v_lshl_add_u32 v176, v180, 4, v176
    v_add_u32 v22, s74, v176
    buffer_load_dwordx4 v10, s[44:47], s71 offen offset:2048  lds
    s_lshl_b32 s68, s66, 13
    s_add_u32 s68, s68, 32768
    v_lshl_add_u32 v176, v179, 7, s68
    v_lshrrev_b32 v177, 1, v179
    v_lshrrev_b32 v181, 4, v1
    v_xor_b32_e64 v177, v177, v181
    v_lshl_add_u32 v44, v177, 4, v176
    v_xor_b32_e64 v45, 64, v44
    v_add_u32 v48, 0x10000, v44
    v_add_u32 v49, 0x10000, v45
    v_lshrrev_b32_e64 v178, 3, v179
    buffer_load_dwordx4 v11, s[44:47], s71 offen offset:3072  lds
    v_xor_b32 v178, s67, v178
    v_lshlrev_b32 v178, 6, v178
    v_lshrrev_b32_e64 v174, 2, v179
    v_lshl_add_u32 v178, v174, 7, v178
    v_add_u32 v178, 32768, v178
    v_lshl_add_u32 v176, v181, 10, v178
    v_lshl_add_u32 v176, v175, 5, v176
    v_and_b32_e64 v172, 3, v179
    v_lshl_add_u32 v46, v172, 3, v176
    v_xor_b32 v47, 32, v46
    v_add_u32 v50, 0x10000, v46
    s_add_u32 m0, s70, 65536
    s_nop 0
    buffer_load_dwordx4 v4, s[40:43], s77 offen offset:0  lds
    v_add_u32 v51, 0x10000, v47
    v_lshrrev_b32_e64 v176, 1, v1
    v_mul_u32_u24 v176, 3584, v176
    s_mul_i32 s68, s67, 114688
    s_lshl_b32 s69, s63, 7
    s_add_u32 s68, s68, s69
    s_mul_i32 s69, s78, 1792
    s_add_u32 s68, s68, s69
    v_add_u32_e64 v183, s68, v176
    s_mov_b32 s52, s36
    s_and_b32 s53, s37, 0xffff
    buffer_load_dwordx4 v5, s[40:43], s77 offen offset:1024  lds
    s_mov_b32 s54, 33554432
    s_mov_b32 s55, 0x20000
    s_lshl1_add_u32 s84, s61, s66
    s_lshl_b32 s84, s84, 12
    s_lshl_b32 s85, s67, 8
    s_add_u32 s84, s84, s85
    s_add_u32 s84, s84, 10485760
    v_lshl_add_u32 v23, v174, 10, s84
    v_lshl_add_u32 v23, v175, 6, v23
    v_lshl_add_u32 v23, v180, 7, v23
    v_lshl_add_u32 v23, v172, 4, v23
    buffer_load_dwordx4 v6, s[40:43], s77 offen offset:2048  lds
    v_mov_b32 v56, -1
    s_mov_b32 s48, s28
    s_and_b32 s49, s29, 0xffff
    s_mov_b32 s50, 1605632
    s_mov_b32 s51, 0x20000
    s_mov_b32 s56, s32
    s_and_b32 s57, s33, 0xffff
    buffer_load_dwordx4 v7, s[40:43], s77 offen offset:3072  lds
    s_mov_b32 m0, s74
    s_lshl_b32 s68, s66, 4
    v_mov_b32 v150, 0x3fb8aa3b
    s_waitcnt lgkmcnt(0)
    s_lshr_b32 s72, s72, s68
    s_lshl_b32 s72, s72, 16
    s_lshr_b32 s73, s73, s68
    s_lshl_b32 s73, s73, 16
    v_mul_f32_e64 v150, s72, v150
    v_exp_f32 v150, v150
    s_nop 0
    v_cvt_pk_bf16_f32 v150, v150, v150
    v_lshlrev_b32 v24, 16, v150
    v_lshlrev_b32 v25, 16, v150
    s_waitcnt vmcnt(13)
    v_lshlrev_b32 v144, 16, v16
    s_waitcnt vmcnt(12)
    v_lshlrev_b32 v145, 16, v17
    v_pk_mul_f32 v[144:145], v[144:145], v[24:25]
    v_mul_f32_e64 v145, 0.15915494, v145
    v_mul_f32 v144, 0x3fb8aa3b, v144
    v_rndne_f32 v154, v145
    v_exp_f32 v158, v144
    v_sub_f32 v145, v145, v154
    v_cos_f32 v160, v145
    v_sin_f32 v161, v145
    s_nop 0
    v_pk_mul_f32 v[160:161], v[160:161], v[158:159] op_sel_hi:[1,0]
    v_pk_mul_f32 v[150:151], v[160:161], v[160:161] op_sel:[0,0] op_sel_hi:[0,1]
    v_pk_fma_f32 v[162:163], v[160:161], v[160:161], v[150:151] op_sel:[1,1,0] op_sel_hi:[1,0,1] neg_lo:[0,1,0]
    v_pk_mul_f32 v[150:151], v[162:163], v[162:163] op_sel:[0,0] op_sel_hi:[0,1]
    v_pk_fma_f32 v[164:165], v[162:163], v[162:163], v[150:151] op_sel:[1,1,0] op_sel_hi:[1,0,1] neg_lo:[0,1,0]
    v_pk_mul_f32 v[150:151], v[164:165], v[164:165] op_sel:[0,0] op_sel_hi:[0,1]
    v_pk_fma_f32 v[78:79], v[164:165], v[164:165], v[150:151] op_sel:[1,1,0] op_sel_hi:[1,0,1] neg_lo:[0,1,0]
    v_pk_mul_f32 v[150:151], v[78:79], v[78:79] op_sel:[0,0] op_sel_hi:[0,1]
    v_pk_fma_f32 v[80:81], v[78:79], v[78:79], v[150:151] op_sel:[1,1,0] op_sel_hi:[1,0,1] neg_lo:[0,1,0]
    v_pk_mul_f32 v[150:151], v[80:81], v[78:79] op_sel:[0,0] op_sel_hi:[0,1]
    v_pk_fma_f32 v[82:83], v[80:81], v[78:79], v[150:151] op_sel:[1,1,0] op_sel_hi:[1,0,1] neg_lo:[0,1,0]
    v_pk_mul_f32 v[150:151], v[80:81], v[80:81] op_sel:[0,0] op_sel_hi:[0,1]
    v_pk_fma_f32 v[84:85], v[80:81], v[80:81], v[150:151] op_sel:[1,1,0] op_sel_hi:[1,0,1] neg_lo:[0,1,0]
    v_pk_mul_f32 v[150:151], v[84:85], v[78:79] op_sel:[0,0] op_sel_hi:[0,1]
    v_pk_fma_f32 v[86:87], v[84:85], v[78:79], v[150:151] op_sel:[1,1,0] op_sel_hi:[1,0,1] neg_lo:[0,1,0]
    v_pk_mul_f32 v[150:151], v[84:85], v[80:81] op_sel:[0,0] op_sel_hi:[0,1]
    v_pk_fma_f32 v[88:89], v[84:85], v[80:81], v[150:151] op_sel:[1,1,0] op_sel_hi:[1,0,1] neg_lo:[0,1,0]
    v_pk_mul_f32 v[150:151], v[84:85], v[82:83] op_sel:[0,0] op_sel_hi:[0,1]
    v_pk_fma_f32 v[90:91], v[84:85], v[82:83], v[150:151] op_sel:[1,1,0] op_sel_hi:[1,0,1] neg_lo:[0,1,0]
    v_pk_mul_f32 v[150:151], v[84:85], v[84:85] op_sel:[0,0] op_sel_hi:[0,1]
    v_pk_fma_f32 v[166:167], v[84:85], v[84:85], v[150:151] op_sel:[1,1,0] op_sel_hi:[1,0,1] neg_lo:[0,1,0]
    v_cvt_pk_bf16_f32 v152, 1.0, 0
    v_cvt_pk_bf16_f32 v153, v78, v79
    v_cvt_pk_bf16_f32 v154, v80, v81
    v_cvt_pk_bf16_f32 v155, v82, v83
    v_cvt_pk_bf16_f32 v156, v84, v85
    v_cvt_pk_bf16_f32 v157, v86, v87
    v_cvt_pk_bf16_f32 v158, v88, v89
    v_cvt_pk_bf16_f32 v159, v90, v91
    ds_write_addtid_b32 v152 offset:0
    ds_write_addtid_b32 v153 offset:272
    ds_write_addtid_b32 v154 offset:544
    ds_write_addtid_b32 v155 offset:816
    ds_write_addtid_b32 v156 offset:1088
    ds_write_addtid_b32 v157 offset:1360
    ds_write_addtid_b32 v158 offset:1632
    ds_write_addtid_b32 v159 offset:1904
    v_pk_mul_f32 v[150:151], v[78:79], v[166:167] op_sel:[0,0] op_sel_hi:[0,1]
    v_pk_fma_f32 v[78:79], v[78:79], v[166:167], v[150:151] op_sel:[1,1,0] op_sel_hi:[1,0,1] neg_lo:[0,1,0]
    v_pk_mul_f32 v[150:151], v[80:81], v[166:167] op_sel:[0,0] op_sel_hi:[0,1]
    v_pk_fma_f32 v[80:81], v[80:81], v[166:167], v[150:151] op_sel:[1,1,0] op_sel_hi:[1,0,1] neg_lo:[0,1,0]
    v_pk_mul_f32 v[150:151], v[82:83], v[166:167] op_sel:[0,0] op_sel_hi:[0,1]
    v_pk_fma_f32 v[82:83], v[82:83], v[166:167], v[150:151] op_sel:[1,1,0] op_sel_hi:[1,0,1] neg_lo:[0,1,0]
    v_pk_mul_f32 v[150:151], v[84:85], v[166:167] op_sel:[0,0] op_sel_hi:[0,1]
    v_pk_fma_f32 v[84:85], v[84:85], v[166:167], v[150:151] op_sel:[1,1,0] op_sel_hi:[1,0,1] neg_lo:[0,1,0]
    v_pk_mul_f32 v[150:151], v[86:87], v[166:167] op_sel:[0,0] op_sel_hi:[0,1]
    v_pk_fma_f32 v[86:87], v[86:87], v[166:167], v[150:151] op_sel:[1,1,0] op_sel_hi:[1,0,1] neg_lo:[0,1,0]
    v_pk_mul_f32 v[150:151], v[88:89], v[166:167] op_sel:[0,0] op_sel_hi:[0,1]
    v_pk_fma_f32 v[88:89], v[88:89], v[166:167], v[150:151] op_sel:[1,1,0] op_sel_hi:[1,0,1] neg_lo:[0,1,0]
    v_pk_mul_f32 v[150:151], v[90:91], v[166:167] op_sel:[0,0] op_sel_hi:[0,1]
    v_pk_fma_f32 v[90:91], v[90:91], v[166:167], v[150:151] op_sel:[1,1,0] op_sel_hi:[1,0,1] neg_lo:[0,1,0]
    v_cvt_pk_bf16_f32 v152, v166, v167
    v_cvt_pk_bf16_f32 v153, v78, v79
    v_cvt_pk_bf16_f32 v154, v80, v81
    v_cvt_pk_bf16_f32 v155, v82, v83
    v_cvt_pk_bf16_f32 v156, v84, v85
    v_cvt_pk_bf16_f32 v157, v86, v87
    v_cvt_pk_bf16_f32 v158, v88, v89
    v_cvt_pk_bf16_f32 v159, v90, v91
    ds_write_addtid_b32 v152 offset:2176
    ds_write_addtid_b32 v153 offset:2448
    ds_write_addtid_b32 v154 offset:2720
    ds_write_addtid_b32 v155 offset:2992
    ds_write_addtid_b32 v156 offset:3264
    ds_write_addtid_b32 v157 offset:3536
    ds_write_addtid_b32 v158 offset:3808
    ds_write_addtid_b32 v159 offset:4080
    v_pk_mul_f32 v[150:151], v[166:167], v[166:167] op_sel:[0,0] op_sel_hi:[0,1]
    v_pk_fma_f32 v[76:77], v[166:167], v[166:167], v[150:151] op_sel:[1,1,0] op_sel_hi:[1,0,1] neg_lo:[0,1,0]
    v_pk_mul_f32 v[150:151], v[78:79], v[166:167] op_sel:[0,0] op_sel_hi:[0,1]
    v_pk_fma_f32 v[78:79], v[78:79], v[166:167], v[150:151] op_sel:[1,1,0] op_sel_hi:[1,0,1] neg_lo:[0,1,0]
    v_pk_mul_f32 v[150:151], v[80:81], v[166:167] op_sel:[0,0] op_sel_hi:[0,1]
    v_pk_fma_f32 v[80:81], v[80:81], v[166:167], v[150:151] op_sel:[1,1,0] op_sel_hi:[1,0,1] neg_lo:[0,1,0]
    v_pk_mul_f32 v[150:151], v[82:83], v[166:167] op_sel:[0,0] op_sel_hi:[0,1]
    v_pk_fma_f32 v[82:83], v[82:83], v[166:167], v[150:151] op_sel:[1,1,0] op_sel_hi:[1,0,1] neg_lo:[0,1,0]
    v_pk_mul_f32 v[150:151], v[84:85], v[166:167] op_sel:[0,0] op_sel_hi:[0,1]
    v_pk_fma_f32 v[84:85], v[84:85], v[166:167], v[150:151] op_sel:[1,1,0] op_sel_hi:[1,0,1] neg_lo:[0,1,0]
    v_pk_mul_f32 v[150:151], v[86:87], v[166:167] op_sel:[0,0] op_sel_hi:[0,1]
    v_pk_fma_f32 v[86:87], v[86:87], v[166:167], v[150:151] op_sel:[1,1,0] op_sel_hi:[1,0,1] neg_lo:[0,1,0]
    v_pk_mul_f32 v[150:151], v[88:89], v[166:167] op_sel:[0,0] op_sel_hi:[0,1]
    v_pk_fma_f32 v[88:89], v[88:89], v[166:167], v[150:151] op_sel:[1,1,0] op_sel_hi:[1,0,1] neg_lo:[0,1,0]
    v_pk_mul_f32 v[150:151], v[90:91], v[166:167] op_sel:[0,0] op_sel_hi:[0,1]
    v_pk_fma_f32 v[90:91], v[90:91], v[166:167], v[150:151] op_sel:[1,1,0] op_sel_hi:[1,0,1] neg_lo:[0,1,0]
    v_cvt_pk_bf16_f32 v152, v76, v77
    v_cvt_pk_bf16_f32 v153, v78, v79
    v_cvt_pk_bf16_f32 v154, v80, v81
    v_cvt_pk_bf16_f32 v155, v82, v83
    v_cvt_pk_bf16_f32 v156, v84, v85
    v_cvt_pk_bf16_f32 v157, v86, v87
    v_cvt_pk_bf16_f32 v158, v88, v89
    v_cvt_pk_bf16_f32 v159, v90, v91
    ds_write_addtid_b32 v152 offset:4352
    ds_write_addtid_b32 v153 offset:4624
    ds_write_addtid_b32 v154 offset:4896
    ds_write_addtid_b32 v155 offset:5168
    ds_write_addtid_b32 v156 offset:5440
    ds_write_addtid_b32 v157 offset:5712
    ds_write_addtid_b32 v158 offset:5984
    ds_write_addtid_b32 v159 offset:6256
    buffer_load_dword v3, v183, s[44:47], 0 offen
    v_pk_mul_f32 v[150:151], v[76:77], v[76:77] op_sel:[0,0] op_sel_hi:[0,1]
    v_pk_fma_f32 v[144:145], v[76:77], v[76:77], v[150:151] op_sel:[1,1,0] op_sel_hi:[1,0,1] neg_lo:[0,1,0]
    v_pk_mul_f32 v[150:151], v[76:77], v[166:167] op_sel:[0,0] op_sel_hi:[0,1]
    v_pk_fma_f32 v[76:77], v[76:77], v[166:167], v[150:151] op_sel:[1,1,0] op_sel_hi:[1,0,1] neg_lo:[0,1,0]
    v_pk_mul_f32 v[150:151], v[78:79], v[166:167] op_sel:[0,0] op_sel_hi:[0,1]
    v_pk_fma_f32 v[78:79], v[78:79], v[166:167], v[150:151] op_sel:[1,1,0] op_sel_hi:[1,0,1] neg_lo:[0,1,0]
    v_pk_mul_f32 v[150:151], v[80:81], v[166:167] op_sel:[0,0] op_sel_hi:[0,1]
    v_pk_fma_f32 v[80:81], v[80:81], v[166:167], v[150:151] op_sel:[1,1,0] op_sel_hi:[1,0,1] neg_lo:[0,1,0]
    v_pk_mul_f32 v[150:151], v[82:83], v[166:167] op_sel:[0,0] op_sel_hi:[0,1]
    v_pk_fma_f32 v[82:83], v[82:83], v[166:167], v[150:151] op_sel:[1,1,0] op_sel_hi:[1,0,1] neg_lo:[0,1,0]
    v_pk_mul_f32 v[150:151], v[84:85], v[166:167] op_sel:[0,0] op_sel_hi:[0,1]
    v_pk_fma_f32 v[84:85], v[84:85], v[166:167], v[150:151] op_sel:[1,1,0] op_sel_hi:[1,0,1] neg_lo:[0,1,0]
    v_pk_mul_f32 v[150:151], v[86:87], v[166:167] op_sel:[0,0] op_sel_hi:[0,1]
    v_pk_fma_f32 v[86:87], v[86:87], v[166:167], v[150:151] op_sel:[1,1,0] op_sel_hi:[1,0,1] neg_lo:[0,1,0]
    v_pk_mul_f32 v[150:151], v[88:89], v[166:167] op_sel:[0,0] op_sel_hi:[0,1]
    v_pk_fma_f32 v[88:89], v[88:89], v[166:167], v[150:151] op_sel:[1,1,0] op_sel_hi:[1,0,1] neg_lo:[0,1,0]
    v_pk_mul_f32 v[150:151], v[90:91], v[166:167] op_sel:[0,0] op_sel_hi:[0,1]
    v_pk_fma_f32 v[90:91], v[90:91], v[166:167], v[150:151] op_sel:[1,1,0] op_sel_hi:[1,0,1] neg_lo:[0,1,0]
    v_cvt_pk_bf16_f32 v152, v76, v77
    v_cvt_pk_bf16_f32 v153, v78, v79
    v_cvt_pk_bf16_f32 v154, v80, v81
    v_cvt_pk_bf16_f32 v155, v82, v83
    v_cvt_pk_bf16_f32 v156, v84, v85
    v_cvt_pk_bf16_f32 v157, v86, v87
    v_cvt_pk_bf16_f32 v158, v88, v89
    v_cvt_pk_bf16_f32 v159, v90, v91
    ds_write_addtid_b32 v152 offset:6528
    ds_write_addtid_b32 v153 offset:6800
    ds_write_addtid_b32 v154 offset:7072
    ds_write_addtid_b32 v155 offset:7344
    ds_write_addtid_b32 v156 offset:7616
    ds_write_addtid_b32 v157 offset:7888
    ds_write_addtid_b32 v158 offset:8160
    ds_write_addtid_b32 v159 offset:8432
    ds_read_b128 a[96:99], v22 offset:0
    ds_read_b128 a[100:103], v22 offset:32
    ds_read_b128 a[104:107], v22 offset:64
    ds_read_b128 a[108:111], v22 offset:96
    ds_read_b128 a[112:115], v22 offset:128
    ds_read_b128 a[116:119], v22 offset:160
    ds_read_b128 a[120:123], v22 offset:192
    ds_read_b128 a[124:127], v22 offset:224
    s_waitcnt vmcnt(12)
    v_lshlrev_b32 v146, 16, v18
    s_waitcnt vmcnt(11)
    v_lshlrev_b32 v147, 16, v19
    s_waitcnt vmcnt(10)
    v_lshlrev_b32 v148, 16, v20
    s_waitcnt vmcnt(9)
    v_lshlrev_b32 v149, 16, v21
    v_pk_mul_f32 v[146:147], v[146:147], v[24:25]
    v_pk_mul_f32 v[150:151], v[148:149], v[146:147] op_sel:[0,0] op_sel_hi:[0,1]
    v_pk_fma_f32 v[92:93], v[148:149], v[146:147], v[150:151] op_sel:[1,1,0] op_sel_hi:[1,0,1] neg_lo:[0,1,0]
    v_pk_mul_f32 v[150:151], v[92:93], v[160:161] op_sel:[0,0] op_sel_hi:[0,1]
    v_pk_fma_f32 v[94:95], v[92:93], v[160:161], v[150:151] op_sel:[1,1,0] op_sel_hi:[1,0,1] neg_lo:[0,1,0]
    v_pk_mul_f32 v[150:151], v[92:93], v[162:163] op_sel:[0,0] op_sel_hi:[0,1]
    v_pk_fma_f32 v[96:97], v[92:93], v[162:163], v[150:151] op_sel:[1,1,0] op_sel_hi:[1,0,1] neg_lo:[0,1,0]
    v_pk_mul_f32 v[150:151], v[94:95], v[162:163] op_sel:[0,0] op_sel_hi:[0,1]
    v_pk_fma_f32 v[98:99], v[94:95], v[162:163], v[150:151] op_sel:[1,1,0] op_sel_hi:[1,0,1] neg_lo:[0,1,0]
    v_pk_mul_f32 v[150:151], v[92:93], v[164:165] op_sel:[0,0] op_sel_hi:[0,1]
    v_pk_fma_f32 v[100:101], v[92:93], v[164:165], v[150:151] op_sel:[1,1,0] op_sel_hi:[1,0,1] neg_lo:[0,1,0]
    v_pk_mul_f32 v[150:151], v[94:95], v[164:165] op_sel:[0,0] op_sel_hi:[0,1]
    v_pk_fma_f32 v[102:103], v[94:95], v[164:165], v[150:151] op_sel:[1,1,0] op_sel_hi:[1,0,1] neg_lo:[0,1,0]
    v_pk_mul_f32 v[150:151], v[96:97], v[164:165] op_sel:[0,0] op_sel_hi:[0,1]
    v_pk_fma_f32 v[104:105], v[96:97], v[164:165], v[150:151] op_sel:[1,1,0] op_sel_hi:[1,0,1] neg_lo:[0,1,0]
    v_pk_mul_f32 v[150:151], v[98:99], v[164:165] op_sel:[0,0] op_sel_hi:[0,1]
    v_pk_fma_f32 v[106:107], v[98:99], v[164:165], v[150:151] op_sel:[1,1,0] op_sel_hi:[1,0,1] neg_lo:[0,1,0]
    v_cvt_pk_bf16_f32 v152, v92, -v93
    v_cvt_pk_bf16_f32 v153, v94, -v95
    v_cvt_pk_bf16_f32 v154, v96, -v97
    v_cvt_pk_bf16_f32 v155, v98, -v99
    v_cvt_pk_bf16_f32 v156, v100, -v101
    v_cvt_pk_bf16_f32 v157, v102, -v103
    v_cvt_pk_bf16_f32 v158, v104, -v105
    v_cvt_pk_bf16_f32 v159, v106, -v107
    ds_write_addtid_b32 v152 offset:0
    ds_write_addtid_b32 v153 offset:272
    ds_write_addtid_b32 v154 offset:544
    ds_write_addtid_b32 v155 offset:816
    ds_write_addtid_b32 v156 offset:1088
    ds_write_addtid_b32 v157 offset:1360
    ds_write_addtid_b32 v158 offset:1632
    ds_write_addtid_b32 v159 offset:1904
    v_pk_mul_f32 v[150:151], v[92:93], v[144:145] op_sel:[0,0] op_sel_hi:[0,1]
    v_pk_fma_f32 v[92:93], v[92:93], v[144:145], v[150:151] op_sel:[1,1,0] op_sel_hi:[1,0,1] neg_lo:[0,1,0]
    v_pk_mul_f32 v[150:151], v[100:101], v[144:145] op_sel:[0,0] op_sel_hi:[0,1]
    v_pk_fma_f32 v[100:101], v[100:101], v[144:145], v[150:151] op_sel:[1,1,0] op_sel_hi:[1,0,1] neg_lo:[0,1,0]
    v_pk_mul_f32 v[150:151], v[96:97], v[144:145] op_sel:[0,0] op_sel_hi:[0,1]
    v_pk_fma_f32 v[96:97], v[96:97], v[144:145], v[150:151] op_sel:[1,1,0] op_sel_hi:[1,0,1] neg_lo:[0,1,0]
    v_pk_mul_f32 v[150:151], v[104:105], v[144:145] op_sel:[0,0] op_sel_hi:[0,1]
    v_pk_fma_f32 v[104:105], v[104:105], v[144:145], v[150:151] op_sel:[1,1,0] op_sel_hi:[1,0,1] neg_lo:[0,1,0]
    v_pk_mul_f32 v[150:151], v[92:93], v[144:145] op_sel:[0,0] op_sel_hi:[0,1]
    v_pk_fma_f32 v[76:77], v[92:93], v[144:145], v[150:151] op_sel:[1,1,0] op_sel_hi:[1,0,1] neg_lo:[0,1,0]
    v_pk_mul_f32 v[150:151], v[100:101], v[144:145] op_sel:[0,0] op_sel_hi:[0,1]
    v_pk_fma_f32 v[78:79], v[100:101], v[144:145], v[150:151] op_sel:[1,1,0] op_sel_hi:[1,0,1] neg_lo:[0,1,0]
    v_cvt_pk_bf16_f32 v152, v92, -v93
    v_cvt_pk_bf16_f32 v153, v100, -v101
    v_cvt_pk_bf16_f32 v154, v96, -v97
    v_cvt_pk_bf16_f32 v155, v104, -v105
    v_cvt_pk_bf16_f32 v156, v76, -v77
    v_cvt_pk_bf16_f32 v157, v78, -v79
    ds_write_addtid_b32 v152 offset:2176
    ds_write_addtid_b32 v152 offset:3808
    ds_write_addtid_b32 v153 offset:2720
    ds_write_addtid_b32 v153 offset:3264
    ds_write_addtid_b32 v154 offset:2448
    ds_write_addtid_b32 v155 offset:3536
    ds_write_addtid_b32 v156 offset:4352
    ds_write_addtid_b32 v156 offset:2992
    ds_write_addtid_b32 v157 offset:4624
    s_branch L_pg1
    .p2align 12
L_pad0:
    s_cbranch_execz L_ret
    s_nop 0
L_pg1:
    v_pk_mul_f32 v[150:151], v[76:77], v[144:145] op_sel:[0,0] op_sel_hi:[0,1]
    v_pk_fma_f32 v[76:77], v[76:77], v[144:145], v[150:151] op_sel:[1,1,0] op_sel_hi:[1,0,1] neg_lo:[0,1,0]
    v_pk_mul_f32 v[150:151], v[78:79], v[144:145] op_sel:[0,0] op_sel_hi:[0,1]
    v_pk_fma_f32 v[78:79], v[78:79], v[144:145], v[150:151] op_sel:[1,1,0] op_sel_hi:[1,0,1] neg_lo:[0,1,0]
    v_pk_mul_f32 v[150:151], v[76:77], v[144:145] op_sel:[0,0] op_sel_hi:[0,1]
    v_pk_fma_f32 v[80:81], v[76:77], v[144:145], v[150:151] op_sel:[1,1,0] op_sel_hi:[1,0,1] neg_lo:[0,1,0]
    v_pk_mul_f32 v[150:151], v[80:81], v[144:145] op_sel:[0,0] op_sel_hi:[0,1]
    v_pk_fma_f32 v[82:83], v[80:81], v[144:145], v[150:151] op_sel:[1,1,0] op_sel_hi:[1,0,1] neg_lo:[0,1,0]
    v_pk_mul_f32 v[150:151], v[82:83], v[144:145] op_sel:[0,0] op_sel_hi:[0,1]
    v_pk_fma_f32 v[84:85], v[82:83], v[144:145], v[150:151] op_sel:[1,1,0] op_sel_hi:[1,0,1] neg_lo:[0,1,0]
    v_pk_mul_f32 v[150:151], v[84:85], v[144:145] op_sel:[0,0] op_sel_hi:[0,1]
    v_pk_fma_f32 v[86:87], v[84:85], v[144:145], v[150:151] op_sel:[1,1,0] op_sel_hi:[1,0,1] neg_lo:[0,1,0]
    v_pk_mul_f32 v[150:151], v[86:87], v[144:145] op_sel:[0,0] op_sel_hi:[0,1]
    v_pk_fma_f32 v[88:89], v[86:87], v[144:145], v[150:151] op_sel:[1,1,0] op_sel_hi:[1,0,1] neg_lo:[0,1,0]
    v_cvt_pk_bf16_f32 v152, v76, -v77
    v_cvt_pk_bf16_f32 v153, v78, -v79
    v_cvt_pk_bf16_f32 v154, v80, -v81
    v_cvt_pk_bf16_f32 v155, v82, -v83
    v_cvt_pk_bf16_f32 v156, v84, -v85
    v_cvt_pk_bf16_f32 v157, v86, -v87
    v_cvt_pk_bf16_f32 v158, v88, -v89
    ds_write_addtid_b32 v152 offset:5440
    ds_write_addtid_b32 v153 offset:5712
    ds_write_addtid_b32 v154 offset:6528
    ds_write_addtid_b32 v155 offset:7616
    ds_write_addtid_b32 v156 offset:7072
    ds_write_addtid_b32 v157 offset:8160
    ds_write_addtid_b32 v158 offset:7344
    ds_read_b128 a[128:131], v22 offset:0
    ds_read_b128 a[132:135], v22 offset:32
    ds_read_b128 a[136:139], v22 offset:64
    ds_read_b128 a[140:143], v22 offset:96
    ds_read_b128 a[144:147], v22 offset:128
    ds_read_b128 a[148:151], v22 offset:160
    ds_read_b128 a[152:155], v22 offset:192
    ds_read_b128 a[156:159], v22 offset:224
    v_and_b32 v144, 0xffff0000, v16
    v_and_b32 v145, 0xffff0000, v17
    v_pk_mul_f32 v[144:145], v[144:145], v[24:25]
    v_mul_f32_e64 v145, 0.15915494, v145
    v_mul_f32 v144, 0x3fb8aa3b, v144
    v_rndne_f32 v154, v145
    v_exp_f32 v158, v144
    v_sub_f32 v145, v145, v154
    v_cos_f32 v160, v145
    v_sin_f32 v161, v145
    s_nop 0
    v_pk_mul_f32 v[160:161], v[160:161], v[158:159] op_sel_hi:[1,0]
    v_pk_mul_f32 v[150:151], v[160:161], v[160:161] op_sel:[0,0] op_sel_hi:[0,1]
    v_pk_fma_f32 v[162:163], v[160:161], v[160:161], v[150:151] op_sel:[1,1,0] op_sel_hi:[1,0,1] neg_lo:[0,1,0]
    v_pk_mul_f32 v[150:151], v[162:163], v[162:163] op_sel:[0,0] op_sel_hi:[0,1]
    v_pk_fma_f32 v[164:165], v[162:163], v[162:163], v[150:151] op_sel:[1,1,0] op_sel_hi:[1,0,1] neg_lo:[0,1,0]
    v_pk_mul_f32 v[150:151], v[164:165], v[164:165] op_sel:[0,0] op_sel_hi:[0,1]
    v_pk_fma_f32 v[78:79], v[164:165], v[164:165], v[150:151] op_sel:[1,1,0] op_sel_hi:[1,0,1] neg_lo:[0,1,0]
    v_pk_mul_f32 v[150:151], v[78:79], v[78:79] op_sel:[0,0] op_sel_hi:[0,1]
    v_pk_fma_f32 v[80:81], v[78:79], v[78:79], v[150:151] op_sel:[1,1,0] op_sel_hi:[1,0,1] neg_lo:[0,1,0]
    v_pk_mul_f32 v[150:151], v[80:81], v[78:79] op_sel:[0,0] op_sel_hi:[0,1]
    v_pk_fma_f32 v[82:83], v[80:81], v[78:79], v[150:151] op_sel:[1,1,0] op_sel_hi:[1,0,1] neg_lo:[0,1,0]
    v_pk_mul_f32 v[150:151], v[80:81], v[80:81] op_sel:[0,0] op_sel_hi:[0,1]
    v_pk_fma_f32 v[84:85], v[80:81], v[80:81], v[150:151] op_sel:[1,1,0] op_sel_hi:[1,0,1] neg_lo:[0,1,0]
    v_pk_mul_f32 v[150:151], v[84:85], v[78:79] op_sel:[0,0] op_sel_hi:[0,1]
    v_pk_fma_f32 v[86:87], v[84:85], v[78:79], v[150:151] op_sel:[1,1,0] op_sel_hi:[1,0,1] neg_lo:[0,1,0]
    v_pk_mul_f32 v[150:151], v[84:85], v[80:81] op_sel:[0,0] op_sel_hi:[0,1]
    v_pk_fma_f32 v[88:89], v[84:85], v[80:81], v[150:151] op_sel:[1,1,0] op_sel_hi:[1,0,1] neg_lo:[0,1,0]
    v_pk_mul_f32 v[150:151], v[84:85], v[82:83] op_sel:[0,0] op_sel_hi:[0,1]
    v_pk_fma_f32 v[90:91], v[84:85], v[82:83], v[150:151] op_sel:[1,1,0] op_sel_hi:[1,0,1] neg_lo:[0,1,0]
    v_pk_mul_f32 v[150:151], v[84:85], v[84:85] op_sel:[0,0] op_sel_hi:[0,1]
    v_pk_fma_f32 v[166:167], v[84:85], v[84:85], v[150:151] op_sel:[1,1,0] op_sel_hi:[1,0,1] neg_lo:[0,1,0]
    s_nop 0
    s_waitcnt lgkmcnt(7)
    v_mfma_f32_32x32x16_bf16 v[28:43], a[128:131], a[96:99], 0
    v_cvt_pk_bf16_f32 v152, 1.0, 0
    v_cvt_pk_bf16_f32 v153, v78, v79
    v_cvt_pk_bf16_f32 v154, v80, v81
    v_cvt_pk_bf16_f32 v155, v82, v83
    v_cvt_pk_bf16_f32 v156, v84, v85
    v_cvt_pk_bf16_f32 v157, v86, v87
    v_cvt_pk_bf16_f32 v158, v88, v89
    v_cvt_pk_bf16_f32 v159, v90, v91
    ds_write_addtid_b32 v152 offset:0
    ds_write_addtid_b32 v153 offset:272
    ds_write_addtid_b32 v154 offset:544
    ds_write_addtid_b32 v155 offset:816
    ds_write_addtid_b32 v156 offset:1088
    ds_write_addtid_b32 v157 offset:1360
    ds_write_addtid_b32 v158 offset:1632
    ds_write_addtid_b32 v159 offset:1904
    v_pk_mul_f32 v[150:151], v[78:79], v[166:167] op_sel:[0,0] op_sel_hi:[0,1]
    v_pk_fma_f32 v[78:79], v[78:79], v[166:167], v[150:151] op_sel:[1,1,0] op_sel_hi:[1,0,1] neg_lo:[0,1,0]
    v_pk_mul_f32 v[150:151], v[80:81], v[166:167] op_sel:[0,0] op_sel_hi:[0,1]
    v_pk_fma_f32 v[80:81], v[80:81], v[166:167], v[150:151] op_sel:[1,1,0] op_sel_hi:[1,0,1] neg_lo:[0,1,0]
    v_pk_mul_f32 v[150:151], v[82:83], v[166:167] op_sel:[0,0] op_sel_hi:[0,1]
    v_pk_fma_f32 v[82:83], v[82:83], v[166:167], v[150:151] op_sel:[1,1,0] op_sel_hi:[1,0,1] neg_lo:[0,1,0]
    v_pk_mul_f32 v[150:151], v[84:85], v[166:167] op_sel:[0,0] op_sel_hi:[0,1]
    v_pk_fma_f32 v[84:85], v[84:85], v[166:167], v[150:151] op_sel:[1,1,0] op_sel_hi:[1,0,1] neg_lo:[0,1,0]
    v_pk_mul_f32 v[150:151], v[86:87], v[166:167] op_sel:[0,0] op_sel_hi:[0,1]
    v_pk_fma_f32 v[86:87], v[86:87], v[166:167], v[150:151] op_sel:[1,1,0] op_sel_hi:[1,0,1] neg_lo:[0,1,0]
    v_pk_mul_f32 v[150:151], v[88:89], v[166:167] op_sel:[0,0] op_sel_hi:[0,1]
    v_pk_fma_f32 v[88:89], v[88:89], v[166:167], v[150:151] op_sel:[1,1,0] op_sel_hi:[1,0,1] neg_lo:[0,1,0]
    v_pk_mul_f32 v[150:151], v[90:91], v[166:167] op_sel:[0,0] op_sel_hi:[0,1]
    v_pk_fma_f32 v[90:91], v[90:91], v[166:167], v[150:151] op_sel:[1,1,0] op_sel_hi:[1,0,1] neg_lo:[0,1,0]
    s_waitcnt lgkmcnt(14)
    v_mfma_f32_32x32x16_bf16 v[28:43], a[132:135], a[100:103], v[28:43]
    v_cvt_pk_bf16_f32 v152, v166, v167
    v_cvt_pk_bf16_f32 v153, v78, v79
    v_cvt_pk_bf16_f32 v154, v80, v81
    v_cvt_pk_bf16_f32 v155, v82, v83
    v_cvt_pk_bf16_f32 v156, v84, v85
    v_cvt_pk_bf16_f32 v157, v86, v87
    v_cvt_pk_bf16_f32 v158, v88, v89
    v_cvt_pk_bf16_f32 v159, v90, v91
    s_waitcnt lgkmcnt(8)
    v_mfma_f32_32x32x16_bf16 v[28:43], a[156:159], a[124:127], v[28:43]
    ds_write_addtid_b32 v152 offset:2176
    ds_write_addtid_b32 v153 offset:2448
    ds_write_addtid_b32 v154 offset:2720
    ds_write_addtid_b32 v155 offset:2992
    ds_write_addtid_b32 v156 offset:3264
    ds_write_addtid_b32 v157 offset:3536
    ds_write_addtid_b32 v158 offset:3808
    ds_write_addtid_b32 v159 offset:4080
    v_pk_mul_f32 v[150:151], v[166:167], v[166:167] op_sel:[0,0] op_sel_hi:[0,1]
    v_pk_fma_f32 v[76:77], v[166:167], v[166:167], v[150:151] op_sel:[1,1,0] op_sel_hi:[1,0,1] neg_lo:[0,1,0]
    v_pk_mul_f32 v[150:151], v[78:79], v[166:167] op_sel:[0,0] op_sel_hi:[0,1]
    v_pk_fma_f32 v[78:79], v[78:79], v[166:167], v[150:151] op_sel:[1,1,0] op_sel_hi:[1,0,1] neg_lo:[0,1,0]
    v_pk_mul_f32 v[150:151], v[80:81], v[166:167] op_sel:[0,0] op_sel_hi:[0,1]
    v_pk_fma_f32 v[80:81], v[80:81], v[166:167], v[150:151] op_sel:[1,1,0] op_sel_hi:[1,0,1] neg_lo:[0,1,0]
    v_pk_mul_f32 v[150:151], v[82:83], v[166:167] op_sel:[0,0] op_sel_hi:[0,1]
    v_pk_fma_f32 v[82:83], v[82:83], v[166:167], v[150:151] op_sel:[1,1,0] op_sel_hi:[1,0,1] neg_lo:[0,1,0]
    v_pk_mul_f32 v[150:151], v[84:85], v[166:167] op_sel:[0,0] op_sel_hi:[0,1]
    v_pk_fma_f32 v[84:85], v[84:85], v[166:167], v[150:151] op_sel:[1,1,0] op_sel_hi:[1,0,1] neg_lo:[0,1,0]
    v_pk_mul_f32 v[150:151], v[86:87], v[166:167] op_sel:[0,0] op_sel_hi:[0,1]
    v_pk_fma_f32 v[86:87], v[86:87], v[166:167], v[150:151] op_sel:[1,1,0] op_sel_hi:[1,0,1] neg_lo:[0,1,0]
    v_pk_mul_f32 v[150:151], v[88:89], v[166:167] op_sel:[0,0] op_sel_hi:[0,1]
    v_pk_fma_f32 v[88:89], v[88:89], v[166:167], v[150:151] op_sel:[1,1,0] op_sel_hi:[1,0,1] neg_lo:[0,1,0]
    v_pk_mul_f32 v[150:151], v[90:91], v[166:167] op_sel:[0,0] op_sel_hi:[0,1]
    v_pk_fma_f32 v[90:91], v[90:91], v[166:167], v[150:151] op_sel:[1,1,0] op_sel_hi:[1,0,1] neg_lo:[0,1,0]
    v_mfma_f32_32x32x16_bf16 v[28:43], a[136:139], a[104:107], v[28:43]
    v_cvt_pk_bf16_f32 v152, v76, v77
    v_cvt_pk_bf16_f32 v153, v78, v79
    v_cvt_pk_bf16_f32 v154, v80, v81
    v_cvt_pk_bf16_f32 v155, v82, v83
    v_cvt_pk_bf16_f32 v156, v84, v85
    v_cvt_pk_bf16_f32 v157, v86, v87
    v_cvt_pk_bf16_f32 v158, v88, v89
    v_cvt_pk_bf16_f32 v159, v90, v91
    ds_write_addtid_b32 v152 offset:4352
    ds_write_addtid_b32 v153 offset:4624
    ds_write_addtid_b32 v154 offset:4896
    ds_write_addtid_b32 v155 offset:5168
    ds_write_addtid_b32 v156 offset:5440
    ds_write_addtid_b32 v157 offset:5712
    ds_write_addtid_b32 v158 offset:5984
    ds_write_addtid_b32 v159 offset:6256
    v_pk_mul_f32 v[150:151], v[76:77], v[76:77] op_sel:[0,0] op_sel_hi:[0,1]
    v_pk_fma_f32 v[144:145], v[76:77], v[76:77], v[150:151] op_sel:[1,1,0] op_sel_hi:[1,0,1] neg_lo:[0,1,0]
    v_pk_mul_f32 v[150:151], v[76:77], v[166:167] op_sel:[0,0] op_sel_hi:[0,1]
    v_pk_fma_f32 v[76:77], v[76:77], v[166:167], v[150:151] op_sel:[1,1,0] op_sel_hi:[1,0,1] neg_lo:[0,1,0]
    v_pk_mul_f32 v[150:151], v[78:79], v[166:167] op_sel:[0,0] op_sel_hi:[0,1]
    v_pk_fma_f32 v[78:79], v[78:79], v[166:167], v[150:151] op_sel:[1,1,0] op_sel_hi:[1,0,1] neg_lo:[0,1,0]
    v_pk_mul_f32 v[150:151], v[80:81], v[166:167] op_sel:[0,0] op_sel_hi:[0,1]
    v_pk_fma_f32 v[80:81], v[80:81], v[166:167], v[150:151] op_sel:[1,1,0] op_sel_hi:[1,0,1] neg_lo:[0,1,0]
    v_pk_mul_f32 v[150:151], v[82:83], v[166:167] op_sel:[0,0] op_sel_hi:[0,1]
    v_pk_fma_f32 v[82:83], v[82:83], v[166:167], v[150:151] op_sel:[1,1,0] op_sel_hi:[1,0,1] neg_lo:[0,1,0]
    v_pk_mul_f32 v[150:151], v[84:85], v[166:167] op_sel:[0,0] op_sel_hi:[0,1]
    v_pk_fma_f32 v[84:85], v[84:85], v[166:167], v[150:151] op_sel:[1,1,0] op_sel_hi:[1,0,1] neg_lo:[0,1,0]
    v_pk_mul_f32 v[150:151], v[86:87], v[166:167] op_sel:[0,0] op_sel_hi:[0,1]
    v_pk_fma_f32 v[86:87], v[86:87], v[166:167], v[150:151] op_sel:[1,1,0] op_sel_hi:[1,0,1] neg_lo:[0,1,0]
    v_pk_mul_f32 v[150:151], v[88:89], v[166:167] op_sel:[0,0] op_sel_hi:[0,1]
    v_pk_fma_f32 v[88:89], v[88:89], v[166:167], v[150:151] op_sel:[1,1,0] op_sel_hi:[1,0,1] neg_lo:[0,1,0]
    v_pk_mul_f32 v[150:151], v[90:91], v[166:167] op_sel:[0,0] op_sel_hi:[0,1]
    v_pk_fma_f32 v[90:91], v[90:91], v[166:167], v[150:151] op_sel:[1,1,0] op_sel_hi:[1,0,1] neg_lo:[0,1,0]
    v_mfma_f32_32x32x16_bf16 v[28:43], a[140:143], a[108:111], v[28:43]
    v_cvt_pk_bf16_f32 v152, v76, v77
    v_cvt_pk_bf16_f32 v153, v78, v79
    v_cvt_pk_bf16_f32 v154, v80, v81
    v_cvt_pk_bf16_f32 v155, v82, v83
    v_cvt_pk_bf16_f32 v156, v84, v85
    v_cvt_pk_bf16_f32 v157, v86, v87
    v_cvt_pk_bf16_f32 v158, v88, v89
    v_cvt_pk_bf16_f32 v159, v90, v91
    ds_write_addtid_b32 v152 offset:6528
    ds_write_addtid_b32 v153 offset:6800
    ds_write_addtid_b32 v154 offset:7072
    ds_write_addtid_b32 v155 offset:7344
    ds_write_addtid_b32 v156 offset:7616
    ds_write_addtid_b32 v157 offset:7888
    ds_write_addtid_b32 v158 offset:8160
    ds_write_addtid_b32 v159 offset:8432
    ds_read_b128 a[160:163], v22 offset:0
    ds_read_b128 a[164:167], v22 offset:32
    ds_read_b128 a[168:171], v22 offset:64
    ds_read_b128 a[172:175], v22 offset:96
    ds_read_b128 a[176:179], v22 offset:128
    ds_read_b128 a[180:183], v22 offset:160
    ds_read_b128 a[184:187], v22 offset:192
    ds_read_b128 a[188:191], v22 offset:224
    s_add_u32 m0, s70, 81920
    s_mul_i32 s71, s78, 1792
    buffer_load_dwordx4 v8, s[44:47], s71 offen offset:0  lds
    v_and_b32 v146, 0xffff0000, v18
    v_and_b32 v147, 0xffff0000, v19
    v_and_b32 v148, 0xffff0000, v20
    v_and_b32 v149, 0xffff0000, v21
    v_pk_mul_f32 v[146:147], v[146:147], v[24:25]
    v_pk_mul_f32 v[150:151], v[148:149], v[146:147] op_sel:[0,0] op_sel_hi:[0,1]
    v_pk_fma_f32 v[92:93], v[148:149], v[146:147], v[150:151] op_sel:[1,1,0] op_sel_hi:[1,0,1] neg_lo:[0,1,0]
    v_pk_mul_f32 v[150:151], v[92:93], v[160:161] op_sel:[0,0] op_sel_hi:[0,1]
    v_pk_fma_f32 v[94:95], v[92:93], v[160:161], v[150:151] op_sel:[1,1,0] op_sel_hi:[1,0,1] neg_lo:[0,1,0]
    v_pk_mul_f32 v[150:151], v[92:93], v[162:163] op_sel:[0,0] op_sel_hi:[0,1]
    v_pk_fma_f32 v[96:97], v[92:93], v[162:163], v[150:151] op_sel:[1,1,0] op_sel_hi:[1,0,1] neg_lo:[0,1,0]
    v_pk_mul_f32 v[150:151], v[94:95], v[162:163] op_sel:[0,0] op_sel_hi:[0,1]
    v_pk_fma_f32 v[98:99], v[94:95], v[162:163], v[150:151] op_sel:[1,1,0] op_sel_hi:[1,0,1] neg_lo:[0,1,0]
    v_pk_mul_f32 v[150:151], v[92:93], v[164:165] op_sel:[0,0] op_sel_hi:[0,1]
    v_pk_fma_f32 v[100:101], v[92:93], v[164:165], v[150:151] op_sel:[1,1,0] op_sel_hi:[1,0,1] neg_lo:[0,1,0]
    v_pk_mul_f32 v[150:151], v[94:95], v[164:165] op_sel:[0,0] op_sel_hi:[0,1]
    v_pk_fma_f32 v[102:103], v[94:95], v[164:165], v[150:151] op_sel:[1,1,0] op_sel_hi:[1,0,1] neg_lo:[0,1,0]
    v_pk_mul_f32 v[150:151], v[96:97], v[164:165] op_sel:[0,0] op_sel_hi:[0,1]
    v_pk_fma_f32 v[104:105], v[96:97], v[164:165], v[150:151] op_sel:[1,1,0] op_sel_hi:[1,0,1] neg_lo:[0,1,0]
    v_pk_mul_f32 v[150:151], v[98:99], v[164:165] op_sel:[0,0] op_sel_hi:[0,1]
    v_pk_fma_f32 v[106:107], v[98:99], v[164:165], v[150:151] op_sel:[1,1,0] op_sel_hi:[1,0,1] neg_lo:[0,1,0]
    v_mfma_f32_32x32x16_bf16 v[28:43], a[144:147], a[112:115], v[28:43]
    s_nop 0
    s_mov_b32 m0, s74
    v_cvt_pk_bf16_f32 v152, v92, -v93
    v_cvt_pk_bf16_f32 v153, v94, -v95
    v_cvt_pk_bf16_f32 v154, v96, -v97
    v_cvt_pk_bf16_f32 v155, v98, -v99
    v_cvt_pk_bf16_f32 v156, v100, -v101
    v_cvt_pk_bf16_f32 v157, v102, -v103
    v_cvt_pk_bf16_f32 v158, v104, -v105
    v_cvt_pk_bf16_f32 v159, v106, -v107
    ds_write_addtid_b32 v152 offset:0
    ds_write_addtid_b32 v153 offset:272
    ds_write_addtid_b32 v154 offset:544
    ds_write_addtid_b32 v155 offset:816
    ds_write_addtid_b32 v156 offset:1088
    ds_write_addtid_b32 v157 offset:1360
    ds_write_addtid_b32 v158 offset:1632
    ds_write_addtid_b32 v159 offset:1904
    s_add_u32 m0, s70, 81920
    s_mul_i32 s71, s78, 1792
    buffer_load_dwordx4 v9, s[44:47], s71 offen offset:1024  lds
    v_pk_mul_f32 v[150:151], v[92:93], v[144:145] op_sel:[0,0] op_sel_hi:[0,1]
    v_pk_fma_f32 v[92:93], v[92:93], v[144:145], v[150:151] op_sel:[1,1,0] op_sel_hi:[1,0,1] neg_lo:[0,1,0]
    v_pk_mul_f32 v[150:151], v[100:101], v[144:145] op_sel:[0,0] op_sel_hi:[0,1]
    v_pk_fma_f32 v[100:101], v[100:101], v[144:145], v[150:151] op_sel:[1,1,0] op_sel_hi:[1,0,1] neg_lo:[0,1,0]
    v_pk_mul_f32 v[150:151], v[96:97], v[144:145] op_sel:[0,0] op_sel_hi:[0,1]
    v_pk_fma_f32 v[96:97], v[96:97], v[144:145], v[150:151] op_sel:[1,1,0] op_sel_hi:[1,0,1] neg_lo:[0,1,0]
    v_pk_mul_f32 v[150:151], v[104:105], v[144:145] op_sel:[0,0] op_sel_hi:[0,1]
    v_pk_fma_f32 v[104:105], v[104:105], v[144:145], v[150:151] op_sel:[1,1,0] op_sel_hi:[1,0,1] neg_lo:[0,1,0]
    v_pk_mul_f32 v[150:151], v[92:93], v[144:145] op_sel:[0,0] op_sel_hi:[0,1]
    v_pk_fma_f32 v[76:77], v[92:93], v[144:145], v[150:151] op_sel:[1,1,0] op_sel_hi:[1,0,1] neg_lo:[0,1,0]
    v_pk_mul_f32 v[150:151], v[100:101], v[144:145] op_sel:[0,0] op_sel_hi:[0,1]
    v_pk_fma_f32 v[78:79], v[100:101], v[144:145], v[150:151] op_sel:[1,1,0] op_sel_hi:[1,0,1] neg_lo:[0,1,0]
    v_mfma_f32_32x32x16_bf16 v[28:43], a[148:151], a[116:119], v[28:43]
    s_nop 0
    s_mov_b32 m0, s74
    v_cvt_pk_bf16_f32 v152, v92, -v93
    v_cvt_pk_bf16_f32 v153, v100, -v101
    v_cvt_pk_bf16_f32 v154, v96, -v97
    v_cvt_pk_bf16_f32 v155, v104, -v105
    v_cvt_pk_bf16_f32 v156, v76, -v77
    v_cvt_pk_bf16_f32 v157, v78, -v79
    ds_write_addtid_b32 v152 offset:2176
    ds_write_addtid_b32 v152 offset:3808
    ds_write_addtid_b32 v153 offset:2720
    ds_write_addtid_b32 v153 offset:3264
    ds_write_addtid_b32 v154 offset:2448
    ds_write_addtid_b32 v155 offset:3536
    ds_write_addtid_b32 v156 offset:4352
    ds_write_addtid_b32 v156 offset:2992
    ds_write_addtid_b32 v157 offset:4624
    s_add_u32 m0, s70, 81920
    s_mul_i32 s71, s78, 1792
    buffer_load_dwordx4 v10, s[44:47], s71 offen offset:2048  lds
    v_pk_mul_f32 v[150:151], v[76:77], v[144:145] op_sel:[0,0] op_sel_hi:[0,1]
    v_pk_fma_f32 v[76:77], v[76:77], v[144:145], v[150:151] op_sel:[1,1,0] op_sel_hi:[1,0,1] neg_lo:[0,1,0]
    v_pk_mul_f32 v[150:151], v[78:79], v[144:145] op_sel:[0,0] op_sel_hi:[0,1]
    v_pk_fma_f32 v[78:79], v[78:79], v[144:145], v[150:151] op_sel:[1,1,0] op_sel_hi:[1,0,1] neg_lo:[0,1,0]
    v_pk_mul_f32 v[150:151], v[76:77], v[144:145] op_sel:[0,0] op_sel_hi:[0,1]
    v_pk_fma_f32 v[80:81], v[76:77], v[144:145], v[150:151] op_sel:[1,1,0] op_sel_hi:[1,0,1] neg_lo:[0,1,0]
    v_pk_mul_f32 v[150:151], v[80:81], v[144:145] op_sel:[0,0] op_sel_hi:[0,1]
    v_pk_fma_f32 v[82:83], v[80:81], v[144:145], v[150:151] op_sel:[1,1,0] op_sel_hi:[1,0,1] neg_lo:[0,1,0]
    v_pk_mul_f32 v[150:151], v[82:83], v[144:145] op_sel:[0,0] op_sel_hi:[0,1]
    v_pk_fma_f32 v[84:85], v[82:83], v[144:145], v[150:151] op_sel:[1,1,0] op_sel_hi:[1,0,1] neg_lo:[0,1,0]
    v_pk_mul_f32 v[150:151], v[84:85], v[144:145] op_sel:[0,0] op_sel_hi:[0,1]
    v_pk_fma_f32 v[86:87], v[84:85], v[144:145], v[150:151] op_sel:[1,1,0] op_sel_hi:[1,0,1] neg_lo:[0,1,0]
    v_pk_mul_f32 v[150:151], v[86:87], v[144:145] op_sel:[0,0] op_sel_hi:[0,1]
    v_pk_fma_f32 v[88:89], v[86:87], v[144:145], v[150:151] op_sel:[1,1,0] op_sel_hi:[1,0,1] neg_lo:[0,1,0]
    v_mfma_f32_32x32x16_bf16 v[28:43], a[152:155], a[120:123], v[28:43]
    s_nop 0
    s_mov_b32 m0, s74
    v_cvt_pk_bf16_f32 v152, v76, -v77
    v_cvt_pk_bf16_f32 v153, v78, -v79
    v_cvt_pk_bf16_f32 v154, v80, -v81
    v_cvt_pk_bf16_f32 v155, v82, -v83
    v_cvt_pk_bf16_f32 v156, v84, -v85
    v_cvt_pk_bf16_f32 v157, v86, -v87
    v_cvt_pk_bf16_f32 v158, v88, -v89
    ds_write_addtid_b32 v152 offset:5440
    ds_write_addtid_b32 v153 offset:5712
    ds_write_addtid_b32 v154 offset:6528
    ds_write_addtid_b32 v155 offset:7616
    ds_write_addtid_b32 v156 offset:7072
    ds_write_addtid_b32 v157 offset:8160
    ds_write_addtid_b32 v158 offset:7344
    ds_read_b128 a[192:195], v22 offset:0
    ds_read_b128 a[196:199], v22 offset:32
    ds_read_b128 a[200:203], v22 offset:64
    ds_read_b128 a[204:207], v22 offset:96
    ds_read_b128 a[208:211], v22 offset:128
    ds_read_b128 a[212:215], v22 offset:160
    ds_read_b128 a[216:219], v22 offset:192
    ds_read_b128 a[220:223], v22 offset:224
    s_add_u32 m0, s70, 81920
    s_mul_i32 s71, s78, 1792
    buffer_load_dwordx4 v11, s[44:47], s71 offen offset:3072  lds
    s_add_u32 m0, s70, 98304
    s_nop 0
    buffer_load_dwordx4 v4, s[40:43], s78 offen offset:0  lds
    s_add_u32 m0, s70, 98304
    s_nop 0
    buffer_load_dwordx4 v5, s[40:43], s78 offen offset:1024  lds
    s_waitcnt lgkmcnt(7)
    v_mfma_f32_32x32x16_bf16 v[28:43], a[192:195], a[160:163], v[28:43]
    s_add_u32 m0, s70, 98304
    s_nop 0
    buffer_load_dwordx4 v6, s[40:43], s78 offen offset:2048  lds
    s_lshl_b32 s38, s60, 11
    s_add_u32 s38, s38, 24576
    v_add_u32_e64 v164, s38, v2
    s_waitcnt lgkmcnt(6)
    v_mfma_f32_32x32x16_bf16 v[28:43], a[196:199], a[164:167], v[28:43]
    buffer_load_dwordx4 v7, s[40:43], s78 offen offset:3072  lds
    v_xor_b32 v165, 0x800, v164
    s_cmp_eq_u32 s67, 0
    s_cselect_b64 s[22:23], -1, 0
    s_mul_i32 s38, s66, 4160
    s_waitcnt lgkmcnt(5)
    v_mfma_f32_32x32x16_bf16 v[28:43], a[200:203], a[168:171], v[28:43]
    s_waitcnt vmcnt(9)
    s_barrier
    s_add_u32 m0, s70, 114688
    s_nop 0
    buffer_load_dwordx4 v4, s[40:43], s79 offen offset:0  lds
    ds_read_b64_tr_b16 a[224:225], v46 offset:16384
    ds_read_b64_tr_b16 a[226:227], v46 offset:16896
    ds_read_b128 a[0:3], v44 offset:32768
    s_waitcnt lgkmcnt(7)
    v_mfma_f32_32x32x16_bf16 v[28:43], a[204:207], a[172:175], v[28:43]
    buffer_load_dwordx4 v5, s[40:43], s79 offen offset:1024  lds
    s_add_u32 s38, s38, 64
    v_and_b32 v167, 31, v1
    v_lshl_add_u32 v166, v167, 4, s38
    s_waitcnt lgkmcnt(6)
    v_mfma_f32_32x32x16_bf16 v[28:43], a[208:211], a[176:179], v[28:43]
    buffer_load_dwordx4 v6, s[40:43], s79 offen offset:2048  lds
    ds_read_b64_tr_b16 a[228:229], v46 offset:24576
    ds_read_b64_tr_b16 a[230:231], v46 offset:25088
    ds_read_b128 a[4:7], v44 offset:34816
    v_lshrrev_b32_e64 v168, 5, v1
    v_lshl_add_u32 v169, v168, 3, v166
    s_waitcnt lgkmcnt(8)
    v_mfma_f32_32x32x16_bf16 v[28:43], a[212:215], a[180:183], v[28:43]
    buffer_load_dwordx4 v7, s[40:43], s79 offen offset:3072  lds
    v_cndmask_b32 v169, v165, v169, s[22:23]
    v_lshl_add_u32 v171, v168, 9, v166
    v_cndmask_b32 v171, v171, v165, s[22:23]
    s_waitcnt lgkmcnt(7)
    v_mfma_f32_32x32x16_bf16 v[28:43], a[216:219], a[184:187], v[28:43]
    ds_read_b128 a[8:11], v44 offset:36864
    ds_read_b128 a[12:15], v44 offset:38912
    ds_read_b64_tr_b16 a[232:233], v47 offset:16384
    ds_read_b64_tr_b16 a[234:235], v47 offset:16896
    ds_read_b64_tr_b16 a[236:237], v47 offset:24576
    ds_read_b64_tr_b16 a[238:239], v47 offset:25088
    s_add_u32 m0, s70, 131072
    s_mul_i32 s71, s79, 1792
    s_waitcnt lgkmcnt(12)
    v_mfma_f32_32x32x16_bf16 v[28:43], a[220:223], a[188:191], v[28:43]
    v_subrev_u32 v167, 2048, v165
    v_cndmask_b32 v170, v171, v167, s[22:23]
    v_cmp_eq_u32 s[26:27], 0, v1
    buffer_load_dwordx4 v8, s[44:47], s71 offen offset:0  lds
    s_waitcnt lgkmcnt(4)
    ds_read_b64_tr_b16 a[240:241], v46 offset:20480
    ds_read_b64_tr_b16 a[242:243], v46 offset:20992
    v_mfma_f32_16x16x32_bf16 v[188:191], a[224:227], a[0:3], 0
    v_cmp_lt_u32 s[30:31], 31, v1
    v_mov_b32_e64 v167, s73
    v_mfma_f32_16x16x32_bf16 v[204:207], a[228:231], a[0:3], 0
    ds_read_b128 a[16:19], v45 offset:32768
    v_and_b32_e64 v168, 1, v1
    v_mfma_f32_16x16x32_bf16 v[196:199], a[224:227], a[4:7], 0
    v_cndmask_b32 v167, 0, v167, s[26:27]
    v_cmp_eq_u32 s[24:25], 0, v168
    v_mfma_f32_16x16x32_bf16 v[212:215], a[228:231], a[4:7], 0
    buffer_load_dwordx4 v9, s[44:47], s71 offen offset:1024  lds
    ds_read_b64_tr_b16 a[244:245], v46 offset:28672
    v_mfma_f32_16x16x32_bf16 v[220:223], a[224:227], a[8:11], 0
    ds_read_b64_tr_b16 a[246:247], v46 offset:29184
    v_cndmask_b32 v156, v28, v36, s[22:23]
    v_mfma_f32_16x16x32_bf16 v[236:239], a[228:231], a[8:11], 0
    ds_read_b128 a[20:23], v45 offset:34816
    v_cndmask_b32 v157, v29, v37, s[22:23]
    v_mfma_f32_16x16x32_bf16 v[228:231], a[224:227], a[12:15], 0
    buffer_load_dwordx4 v10, s[44:47], s71 offen offset:2048  lds
    v_mfma_f32_16x16x32_bf16 v[244:247], a[228:231], a[12:15], 0
    s_waitcnt lgkmcnt(6)
    ds_read_b128 a[24:27], v45 offset:36864
    v_mfma_f32_16x16x32_bf16 v[192:195], a[232:235], a[0:3], 0
    ds_read_b128 a[28:31], v45 offset:38912
    v_cndmask_b32 v158, v30, v38, s[22:23]
    v_mfma_f32_16x16x32_bf16 v[208:211], a[236:239], a[0:3], 0
    ds_read_b64_tr_b16 a[224:225], v47 offset:20480
    v_mfma_f32_16x16x32_bf16 v[200:203], a[232:235], a[4:7], 0
    v_cndmask_b32 v159, v31, v39, s[22:23]
    v_cndmask_b32 v160, v32, v40, s[22:23]
    v_mfma_f32_16x16x32_bf16 v[216:219], a[236:239], a[4:7], 0
    buffer_load_dwordx4 v11, s[44:47], s71 offen offset:3072  lds
    v_mfma_f32_16x16x32_bf16 v[224:227], a[232:235], a[8:11], 0
    ds_read_b64_tr_b16 a[226:227], v47 offset:20992
    ds_read_b64_tr_b16 a[228:229], v47 offset:28672
    v_mfma_f32_16x16x32_bf16 v[240:243], a[236:239], a[8:11], 0
    v_cndmask_b32 v161, v33, v41, s[22:23]
    s_add_u32 m0, s70, 147456
    v_mfma_f32_16x16x32_bf16 v[232:235], a[232:235], a[12:15], 0
    ds_read_b64_tr_b16 a[230:231], v47 offset:29184
    v_cndmask_b32 v162, v34, v42, s[22:23]
    v_mfma_f32_16x16x32_bf16 v[248:251], a[236:239], a[12:15], 0
    buffer_load_dwordx4 v4, s[40:43], s80 offen offset:0  lds
    s_waitcnt lgkmcnt(4)
    v_mfma_f32_16x16x32_bf16 v[188:191], a[240:243], a[16:19], v[188:191]
    v_mfma_f32_16x16x32_bf16 v[204:207], a[244:247], a[16:19], v[204:207]
    s_waitcnt vmcnt(9) lgkmcnt(0)
    s_barrier
    ds_read_b64_tr_b16 a[232:233], v46 offset:49152
    v_mfma_f32_16x16x32_bf16 v[196:199], a[240:243], a[20:23], v[196:199]
    ds_read_b64_tr_b16 a[234:235], v46 offset:49664
    ds_read_b128 a[32:35], v48 offset:0
    v_mfma_f32_16x16x32_bf16 v[212:215], a[244:247], a[20:23], v[212:215]
    v_cndmask_b32 v163, v35, v43, s[22:23]
    v_cndmask_b32 v28, v36, v28, s[22:23]
    v_mfma_f32_16x16x32_bf16 v[220:223], a[240:243], a[24:27], v[220:223]
    buffer_load_dwordx4 v5, s[40:43], s80 offen offset:1024  lds
    ds_read_b64_tr_b16 a[236:237], v46 offset:57344
    v_mfma_f32_16x16x32_bf16 v[236:239], a[244:247], a[24:27], v[236:239]
    ds_read_b64_tr_b16 a[238:239], v46 offset:57856
    v_cndmask_b32 v29, v37, v29, s[22:23]
    v_mfma_f32_16x16x32_bf16 v[228:231], a[240:243], a[28:31], v[228:231]
    ds_read_b128 a[36:39], v48 offset:2048
    v_cndmask_b32 v30, v38, v30, s[22:23]
    v_mfma_f32_16x16x32_bf16 v[244:247], a[244:247], a[28:31], v[244:247]
    buffer_load_dwordx4 v6, s[40:43], s80 offen offset:2048  lds
    ds_read_b128 a[40:43], v48 offset:4096
    v_mfma_f32_16x16x32_bf16 v[192:195], a[224:227], a[16:19], v[192:195]
    ds_read_b128 a[44:47], v48 offset:6144
    v_cndmask_b32 v31, v39, v31, s[22:23]
    v_mfma_f32_16x16x32_bf16 v[208:211], a[228:231], a[16:19], v[208:211]
    ds_read_b64_tr_b16 a[240:241], v47 offset:49152
    v_mfma_f32_16x16x32_bf16 v[200:203], a[224:227], a[20:23], v[200:203]
    v_cndmask_b32 v32, v40, v32, s[22:23]
    v_cndmask_b32 v33, v41, v33, s[22:23]
    v_mfma_f32_16x16x32_bf16 v[216:219], a[228:231], a[20:23], v[216:219]
    buffer_load_dwordx4 v7, s[40:43], s80 offen offset:3072  lds
    ds_read_b64_tr_b16 a[242:243], v47 offset:49664
    v_mfma_f32_16x16x32_bf16 v[224:227], a[224:227], a[24:27], v[224:227]
    ds_read_b64_tr_b16 a[244:245], v47 offset:57344
    v_cndmask_b32 v34, v42, v34, s[22:23]
    v_mfma_f32_16x16x32_bf16 v[240:243], a[228:231], a[24:27], v[240:243]
    s_add_u32 m0, s70, 49152
    s_mul_i32 s71, s80, 1792
    v_mfma_f32_16x16x32_bf16 v[232:235], a[224:227], a[28:31], v[232:235]
    ds_read_b64_tr_b16 a[246:247], v47 offset:57856
    v_cndmask_b32 v35, v43, v35, s[22:23]
    v_mfma_f32_16x16x32_bf16 v[248:251], a[228:231], a[28:31], v[248:251]
    buffer_load_dwordx4 v8, s[44:47], s71 offen offset:0  lds
    s_nop 0
    s_waitcnt lgkmcnt(4)
    v_mfma_f32_16x16x32_bf16 v[188:191], a[232:235], a[32:35], v[188:191]
    ds_write_b128 v164, v[160:163] offset:1024
    v_mfma_f32_16x16x32_bf16 v[204:207], a[236:239], a[32:35], v[204:207]
    s_mov_b64 exec, 0
    s_sub_u32 s69, s60, 4
L_ret:
    s_add_u32 s69, s69, 4
    s_cmp_eq_u32 s69, 0
    s_cbranch_scc1 L_pad2
    s_cmp_eq_u32 s69, 1
    s_cbranch_scc1 L_pad3
    s_cmp_eq_u32 s69, 2
    s_cbranch_scc1 L_pad4
    s_cmp_eq_u32 s69, 3
    s_cbranch_scc1 L_pad5
    s_mov_b64 exec, -1
    v_mfma_f32_16x16x32_bf16 v[196:199], a[232:235], a[36:39], v[196:199]
    ds_write_b128 v164, v[156:159]
    v_mfma_f32_16x16x32_bf16 v[212:215], a[236:239], a[36:39], v[212:215]
    ds_read_b64_tr_b16 a[224:225], v46 offset:53248
    ds_read_b64_tr_b16 a[226:227], v46 offset:53760
    v_mfma_f32_16x16x32_bf16 v[220:223], a[232:235], a[40:43], v[220:223]
    ds_read_b128 a[48:51], v49 offset:0
    buffer_load_dwordx4 v9, s[44:47], s71 offen offset:1024  lds
    v_mfma_f32_16x16x32_bf16 v[236:239], a[236:239], a[40:43], v[236:239]
    ds_read_b64_tr_b16 a[228:229], v46 offset:61440
    ds_read_b64_tr_b16 a[230:231], v46 offset:61952
    v_mfma_f32_16x16x32_bf16 v[228:231], a[232:235], a[44:47], v[228:231]
    ds_read_b128 a[52:55], v49 offset:2048
    v_mfma_f32_16x16x32_bf16 v[244:247], a[236:239], a[44:47], v[244:247]
    buffer_load_dwordx4 v10, s[44:47], s71 offen offset:2048  lds
    s_waitcnt lgkmcnt(8)
    v_mfma_f32_16x16x32_bf16 v[192:195], a[240:243], a[32:35], v[192:195]
    ds_read_b128 a[56:59], v49 offset:4096
    v_mfma_f32_16x16x32_bf16 v[208:211], a[244:247], a[32:35], v[208:211]
    ds_read_b128 a[60:63], v49 offset:6144
    v_mfma_f32_16x16x32_bf16 v[200:203], a[240:243], a[36:39], v[200:203]
    ds_read_b64_tr_b16 a[232:233], v47 offset:53248
    v_mfma_f32_16x16x32_bf16 v[216:219], a[244:247], a[36:39], v[216:219]
    buffer_load_dwordx4 v11, s[44:47], s71 offen offset:3072  lds
    v_mfma_f32_16x16x32_bf16 v[224:227], a[240:243], a[40:43], v[224:227]
    ds_read_b64_tr_b16 a[234:235], v47 offset:53760
    v_mfma_f32_16x16x32_bf16 v[240:243], a[244:247], a[40:43], v[240:243]
    ds_read_b64_tr_b16 a[236:237], v47 offset:61440
    s_add_u32 m0, s70, 65536
    v_mfma_f32_16x16x32_bf16 v[232:235], a[240:243], a[44:47], v[232:235]
    ds_read_b64_tr_b16 a[238:239], v47 offset:61952
    v_mfma_f32_16x16x32_bf16 v[248:251], a[244:247], a[44:47], v[248:251]
    buffer_load_dwordx4 v4, s[40:43], s81 offen offset:0  lds
    s_waitcnt lgkmcnt(4)
    v_mfma_f32_16x16x32_bf16 v[188:191], a[224:227], a[48:51], v[188:191]
    v_mfma_f32_16x16x32_bf16 v[204:207], a[228:231], a[48:51], v[204:207]
    s_waitcnt vmcnt(9) lgkmcnt(0)
    s_barrier
    ds_read_b64_tr_b16 a[240:241], v50 offset:32768
    v_mfma_f32_16x16x32_bf16 v[196:199], a[224:227], a[52:55], v[196:199]
    ds_read_b64_tr_b16 a[242:243], v50 offset:33280
    ds_read_b128 v[36:39], v165
    v_mfma_f32_16x16x32_bf16 v[212:215], a[228:231], a[52:55], v[212:215]
    ds_read_b128 v[40:43], v165 offset:1024
    ds_read_b128 a[64:67], v48 offset:16384
L_pad1:
    s_cbranch_execz L_ret
    s_nop 0
    v_mfma_f32_16x16x32_bf16 v[220:223], a[224:227], a[56:59], v[220:223]
    buffer_load_dwordx4 v5, s[40:43], s81 offen offset:1024  lds
    ds_read_b64_tr_b16 a[244:245], v50 offset:40960
    v_mfma_f32_16x16x32_bf16 v[236:239], a[228:231], a[56:59], v[236:239]
    ds_read_b64_tr_b16 a[246:247], v50 offset:41472
    ds_read_b128 a[68:71], v48 offset:18432
    v_mfma_f32_16x16x32_bf16 v[228:231], a[224:227], a[60:63], v[228:231]
    buffer_load_dwordx4 v6, s[40:43], s81 offen offset:2048  lds
    s_waitcnt lgkmcnt(4)
    v_mfma_f32_16x16x32_bf16 v[244:247], a[228:231], a[60:63], v[244:247]
    v_add_f32 v28, v28, v36
    v_add_f32 v29, v29, v37
    v_add_f32 v30, v30, v38
    v_mfma_f32_16x16x32_bf16 v[192:195], a[232:235], a[48:51], v[192:195]
    ds_read_b128 a[72:75], v48 offset:20480
    ds_read_b128 a[76:79], v48 offset:22528
    v_add_f32_e64 v31, v31, v39
    v_mfma_f32_16x16x32_bf16 v[208:211], a[236:239], a[48:51], v[208:211]
    v_add_f32 v32, v32, v40
    v_add_f32 v33, v33, v41
    v_add_f32 v34, v34, v42
    v_add_f32 v35, v35, v43
    v_mfma_f32_16x16x32_bf16 v[200:203], a[232:235], a[52:55], v[200:203]
    ds_read_b64_tr_b16 a[224:225], v51 offset:32768
    buffer_load_dwordx4 v7, s[40:43], s81 offen offset:3072  lds
    v_add_f32_e64 v167, v28, v167
    v_mfma_f32_16x16x32_bf16 v[216:219], a[236:239], a[52:55], v[216:219]
    v_cndmask_b32 v36, v28, v32, s[26:27]
    v_cndmask_b32 v37, v32, v34, s[26:27]
    v_cndmask_b32 v38, v34, v35, s[26:27]
    v_mfma_f32_16x16x32_bf16 v[224:227], a[232:235], a[56:59], v[224:227]
    ds_read_b64_tr_b16 a[226:227], v51 offset:33280
    ds_read_b64_tr_b16 a[228:229], v51 offset:40960
    v_cvt_pk_bf16_f32 v156, v167, v29
    v_cvt_pk_bf16_f32 v157, v30, v31
    v_mfma_f32_16x16x32_bf16 v[240:243], a[236:239], a[56:59], v[240:243]
    s_add_u32 m0, s70, 32768
    s_mul_i32 s71, s81, 1792
    ds_read_b64_tr_b16 a[230:231], v51 offset:41472
    v_mfma_f32_16x16x32_bf16 v[232:235], a[232:235], a[60:63], v[232:235]
    buffer_load_dwordx4 v8, s[44:47], s71 offen offset:0  lds
    v_cvt_pk_bf16_f32 v158, v32, v32
    v_mov_b32_dpp v166, v36 wave_rol:1 row_mask:0xf bank_mask:0xf
    v_mov_b32_dpp v168, v37 wave_rol:1 row_mask:0xf bank_mask:0xf
    v_mov_b32_dpp v164, v38 wave_rol:1 row_mask:0xf bank_mask:0xf
    v_mfma_f32_16x16x32_bf16 v[248:251], a[236:239], a[60:63], v[248:251]
    s_nop 0
    s_waitcnt lgkmcnt(4)
    ds_read_b64_tr_b16 a[232:233], v50 offset:36864
    v_mfma_f32_16x16x32_bf16 v[188:191], a[240:243], a[64:67], v[188:191]
    ds_read_b64_tr_b16 a[234:235], v50 offset:37376
    v_cndmask_b32 v167, v34, v164, s[30:31]
    v_cvt_pk_bf16_f32 v159, v33, v167
    v_cvt_pk_bf16_f32 v36, v28, v28
    v_cvt_pk_bf16_f32 v37, v28, v29
    v_mfma_f32_16x16x32_bf16 v[204:207], a[244:247], a[64:67], v[204:207]
    ds_read_b128 a[80:83], v49 offset:16384
    buffer_load_dwordx4 v9, s[44:47], s71 offen offset:1024  lds
    v_cvt_pk_bf16_f32 v38, v29, v29
    v_mfma_f32_16x16x32_bf16 v[196:199], a[240:243], a[68:71], v[196:199]
    v_cvt_pk_bf16_f32 v39, v166, v166
    v_cndmask_b32 v28, v168, v32, s[24:25]
    v_cndmask_b32 v29, v164, v34, s[24:25]
    v_mfma_f32_16x16x32_bf16 v[212:215], a[244:247], a[68:71], v[212:215]
    ds_read_b64_tr_b16 a[236:237], v50 offset:45056
    ds_read_b64_tr_b16 a[238:239], v50 offset:45568
    v_cvt_pk_bf16_f32 v40, v32, v32
    v_mfma_f32_16x16x32_bf16 v[220:223], a[240:243], a[72:75], v[220:223]
    v_cvt_pk_bf16_f32 v41, v32, v32
    v_cvt_pk_bf16_f32 v42, v28, v168
    v_cvt_pk_bf16_f32 v43, v168, v168
    v_cvt_pk_bf16_f32 v160, v34, v34
    v_mfma_f32_16x16x32_bf16 v[236:239], a[244:247], a[72:75], v[236:239]
    ds_read_b128 a[84:87], v49 offset:18432
    buffer_load_dwordx4 v10, s[44:47], s71 offen offset:2048  lds
    v_cvt_pk_bf16_f32 v161, v34, v34
    v_mfma_f32_16x16x32_bf16 v[228:231], a[240:243], a[76:79], v[228:231]
    v_cvt_pk_bf16_f32 v162, v29, v164
    v_cvt_pk_bf16_f32 v163, v164, v164
    s_waitcnt lgkmcnt(6)
    v_mfma_f32_16x16x32_bf16 v[244:247], a[244:247], a[76:79], v[244:247]
    ds_write_b128 v170, v[160:163] offset:3072
    v_mfma_f32_16x16x32_bf16 v[192:195], a[224:227], a[64:67], v[192:195]
    ds_write_b128 v170, v[40:43] offset:2048
    v_mfma_f32_16x16x32_bf16 v[208:211], a[228:231], a[64:67], v[208:211]
    ds_write_b128 v171, v[36:39] offset:1024
    v_mfma_f32_16x16x32_bf16 v[200:203], a[224:227], a[68:71], v[200:203]
    ds_write2_b64 v169, v[156:157], v[158:159] offset1:64
    v_mfma_f32_16x16x32_bf16 v[216:219], a[228:231], a[68:71], v[216:219]
    ds_read_b128 a[88:91], v49 offset:20480
    ds_read_b128 a[92:95], v49 offset:22528
    v_mfma_f32_16x16x32_bf16 v[224:227], a[224:227], a[72:75], v[224:227]
    ds_read_b64_tr_b16 a[240:241], v51 offset:36864
    buffer_load_dwordx4 v11, s[44:47], s71 offen offset:3072  lds
    v_mfma_f32_16x16x32_bf16 v[240:243], a[228:231], a[72:75], v[240:243]
    ds_read_b64_tr_b16 a[242:243], v51 offset:37376
    ds_read_b64_tr_b16 a[244:245], v51 offset:45056
    v_mfma_f32_16x16x32_bf16 v[232:235], a[224:227], a[76:79], v[232:235]
    s_add_u32 m0, s70, 81920
    ds_read_b64_tr_b16 a[246:247], v51 offset:45568
    v_mfma_f32_16x16x32_bf16 v[248:251], a[228:231], a[76:79], v[248:251]
    buffer_load_dwordx4 v4, s[40:43], s82 offen offset:0  lds
    s_waitcnt lgkmcnt(4)
    v_mfma_f32_16x16x32_bf16 v[188:191], a[232:235], a[80:83], v[188:191]
    v_mfma_f32_16x16x32_bf16 v[204:207], a[236:239], a[80:83], v[204:207]
    s_waitcnt vmcnt(9) lgkmcnt(0)
    s_barrier
    ds_read_b64_tr_b16 a[224:225], v46 offset:16384
    v_mfma_f32_16x16x32_bf16 v[196:199], a[232:235], a[84:87], v[196:199]
    ds_read_b64_tr_b16 a[226:227], v46 offset:16896
    s_mov_b32 s58, 1835008
    v_mfma_f32_16x16x32_bf16 v[212:215], a[236:239], a[84:87], v[212:215]
    ds_read_b128 a[96:99], v48 offset:49152
    buffer_load_dwordx4 v5, s[40:43], s82 offen offset:1024  lds
    v_mfma_f32_16x16x32_bf16 v[220:223], a[232:235], a[88:91], v[220:223]
    s_mov_b32 s59, 0x20000
    v_mov_b32 v66, 0xbdd2d3e8
    v_mfma_f32_16x16x32_bf16 v[236:239], a[236:239], a[88:91], v[236:239]
    ds_read_b64_tr_b16 a[228:229], v46 offset:24576
    ds_read_b64_tr_b16 a[230:231], v46 offset:25088
    v_mfma_f32_16x16x32_bf16 v[228:231], a[232:235], a[92:95], v[228:231]
    v_mov_b32 v67, 0xbdd2d3e8
    v_mov_b32 v68, 0xc0135761
    v_mfma_f32_16x16x32_bf16 v[244:247], a[236:239], a[92:95], v[244:247]
    ds_read_b128 a[100:103], v48 offset:51200
    buffer_load_dwordx4 v6, s[40:43], s82 offen offset:2048  lds
    v_mov_b32 v69, 0xc0135761
    v_mfma_f32_16x16x32_bf16 v[192:195], a[240:243], a[80:83], v[192:195]
    s_nop 0
    s_mul_i32 s21, s60, 7
    ds_read_b128 a[104:107], v48 offset:53248
    v_mfma_f32_16x16x32_bf16 v[208:211], a[244:247], a[80:83], v[208:211]
    ds_read_b128 a[108:111], v48 offset:55296
    s_mul_i32 s85, s21, 28672
    v_mfma_f32_16x16x32_bf16 v[200:203], a[240:243], a[84:87], v[200:203]
    s_lshl_b32 s84, s64, 7
    ds_read_b64_tr_b16 a[232:233], v47 offset:16384
    v_mfma_f32_16x16x32_bf16 v[216:219], a[244:247], a[84:87], v[216:219]
    buffer_load_dwordx4 v7, s[40:43], s82 offen offset:3072  lds
    s_add_u32 s84, s84, s85
    v_mul_u32_u24 v176, 896, v173
    v_mfma_f32_16x16x32_bf16 v[224:227], a[240:243], a[88:91], v[224:227]
    ds_read_b64_tr_b16 a[234:235], v47 offset:16896
    ds_read_b64_tr_b16 a[236:237], v47 offset:24576
    v_mfma_f32_16x16x32_bf16 v[240:243], a[244:247], a[88:91], v[240:243]
    s_add_u32 m0, s70, 98304
    s_mul_i32 s71, s82, 1792
    ds_read_b64_tr_b16 a[238:239], v47 offset:25088
    v_mfma_f32_16x16x32_bf16 v[232:235], a[240:243], a[92:95], v[232:235]
    buffer_load_dwordx4 v8, s[44:47], s71 offen offset:0  lds
    v_add_u32 v176, s84, v176
    v_mfma_f32_16x16x32_bf16 v[248:251], a[244:247], a[92:95], v[248:251]
    v_lshl_add_u32 v12, v182, 4, v176
    s_waitcnt lgkmcnt(4)
    v_mfma_f32_16x16x32_bf16 v[188:191], a[224:227], a[96:99], v[188:191]
    ds_read_b64_tr_b16 a[240:241], v46 offset:20480
    v_mfma_f32_16x16x32_bf16 v[204:207], a[228:231], a[96:99], v[204:207]
    ds_read_b64_tr_b16 a[242:243], v46 offset:20992
    v_add_u32 v13, 6144, v12
    v_mfma_f32_16x16x32_bf16 v[196:199], a[224:227], a[100:103], v[196:199]
    ds_read_b128 a[112:115], v49 offset:49152
    buffer_load_dwordx4 v9, s[44:47], s71 offen offset:1024  lds
    v_mfma_f32_16x16x32_bf16 v[212:215], a[228:231], a[100:103], v[212:215]
    v_add_u32 v14, 12288, v12
    v_add_u32 v15, 18432, v12
    v_mfma_f32_16x16x32_bf16 v[220:223], a[224:227], a[104:107], v[220:223]
    ds_read_b64_tr_b16 a[244:245], v46 offset:28672
    v_mfma_f32_16x16x32_bf16 v[236:239], a[228:231], a[104:107], v[236:239]
    ds_read_b64_tr_b16 a[246:247], v46 offset:29184
    s_and_b32 s85, s62, 3
    v_mfma_f32_16x16x32_bf16 v[228:231], a[224:227], a[108:111], v[228:231]
    s_and_b32 s20, s61, 7
    ds_read_b128 a[116:119], v49 offset:51200
    v_mfma_f32_16x16x32_bf16 v[244:247], a[228:231], a[108:111], v[244:247]
    buffer_load_dwordx4 v10, s[44:47], s71 offen offset:2048  lds
    s_waitcnt lgkmcnt(6)
    v_mfma_f32_16x16x32_bf16 v[192:195], a[232:235], a[96:99], v[192:195]
    ds_read_b128 a[120:123], v49 offset:53248
    ds_read_b128 a[124:127], v49 offset:55296
    v_mfma_f32_16x16x32_bf16 v[208:211], a[236:239], a[96:99], v[208:211]
    s_sub_u32 s85, s20, 7
    s_min_u32 s20, s20, s85
    s_lshl_b32 s13, s20, 12
    v_mfma_f32_16x16x32_bf16 v[200:203], a[232:235], a[100:103], v[200:203]
    s_mul_i32 s6, s13, 7
    ds_read_b64_tr_b16 a[224:225], v47 offset:20480
    v_mfma_f32_16x16x32_bf16 v[216:219], a[236:239], a[100:103], v[216:219]
    buffer_load_dwordx4 v11, s[44:47], s71 offen offset:3072  lds
    v_mfma_f32_16x16x32_bf16 v[224:227], a[232:235], a[104:107], v[224:227]
    ds_read_b64_tr_b16 a[226:227], v47 offset:20992
    ds_read_b64_tr_b16 a[228:229], v47 offset:28672
    v_mfma_f32_16x16x32_bf16 v[240:243], a[236:239], a[104:107], v[240:243]
    s_add_u32 s85, s13, 4096
    s_cmp_lt_u32 s85, 28672
    s_cselect_b32 s14, s85, 0
    v_mfma_f32_16x16x32_bf16 v[232:235], a[232:235], a[108:111], v[232:235]
    s_add_u32 m0, s70, 114688
    ds_read_b64_tr_b16 a[230:231], v47 offset:29184
    v_mfma_f32_16x16x32_bf16 v[248:251], a[236:239], a[108:111], v[248:251]
    buffer_load_dwordx4 v4, s[40:43], s83 offen offset:0  lds
    s_mul_i32 s7, s14, 7
    s_waitcnt lgkmcnt(4)
    v_mfma_f32_16x16x32_bf16 v[188:191], a[240:243], a[112:115], v[188:191]
    v_mfma_f32_16x16x32_bf16 v[204:207], a[244:247], a[112:115], v[204:207]
    s_waitcnt vmcnt(9) lgkmcnt(0)
    s_barrier
    v_mfma_f32_16x16x32_bf16 v[196:199], a[240:243], a[116:119], v[196:199]
    ds_read_b64_tr_b16 a[232:233], v46 offset:0
    ds_read_b64_tr_b16 a[234:235], v46 offset:512
    v_mfma_f32_16x16x32_bf16 v[212:215], a[244:247], a[116:119], v[212:215]
    ds_read_b128 a[128:131], v44 offset:32768
    buffer_load_dwordx4 v5, s[40:43], s83 offen offset:1024  lds
    v_mfma_f32_16x16x32_bf16 v[220:223], a[240:243], a[120:123], v[220:223]
    s_add_u32 s85, s14, 4096
    s_cmp_lt_u32 s85, 28672
    s_cselect_b32 s15, s85, 0
    ds_read_b64_tr_b16 a[236:237], v46 offset:8192
    v_mfma_f32_16x16x32_bf16 v[236:239], a[244:247], a[120:123], v[236:239]
    ds_read_b64_tr_b16 a[238:239], v46 offset:8704
    s_mul_i32 s8, s15, 7
    v_mfma_f32_16x16x32_bf16 v[228:231], a[240:243], a[124:127], v[228:231]
    ds_read_b128 a[132:135], v44 offset:34816
    buffer_load_dwordx4 v6, s[40:43], s83 offen offset:2048  lds
    v_mfma_f32_16x16x32_bf16 v[244:247], a[244:247], a[124:127], v[244:247]
    s_add_u32 s85, s15, 4096
    s_cmp_lt_u32 s85, 28672
    s_cselect_b32 s16, s85, 0
    v_mfma_f32_16x16x32_bf16 v[192:195], a[224:227], a[112:115], v[192:195]
    ds_read_b128 a[136:139], v44 offset:36864
    v_mfma_f32_16x16x32_bf16 v[208:211], a[228:231], a[112:115], v[208:211]
    ds_read_b128 a[140:143], v44 offset:38912
    s_mul_i32 s9, s16, 7
    v_mfma_f32_16x16x32_bf16 v[200:203], a[224:227], a[116:119], v[200:203]
    ds_read_b64_tr_b16 a[240:241], v47 offset:0
    buffer_load_dwordx4 v7, s[40:43], s83 offen offset:3072  lds
    v_mfma_f32_16x16x32_bf16 v[216:219], a[228:231], a[116:119], v[216:219]
    s_add_u32 s85, s16, 4096
    s_cmp_lt_u32 s85, 28672
    s_cselect_b32 s17, s85, 0
    v_mfma_f32_16x16x32_bf16 v[224:227], a[224:227], a[120:123], v[224:227]
    ds_read_b64_tr_b16 a[242:243], v47 offset:512
    v_mfma_f32_16x16x32_bf16 v[240:243], a[228:231], a[120:123], v[240:243]
    ds_read_b64_tr_b16 a[244:245], v47 offset:8192
    s_mul_i32 s10, s17, 7
    v_mfma_f32_16x16x32_bf16 v[232:235], a[224:227], a[124:127], v[232:235]
    s_add_u32 m0, s70, 131072
    s_mul_i32 s71, s83, 1792
    ds_read_b64_tr_b16 a[246:247], v47 offset:8704
    v_mfma_f32_16x16x32_bf16 v[248:251], a[228:231], a[124:127], v[248:251]
    buffer_load_dwordx4 v8, s[44:47], s71 offen offset:0  lds
    s_waitcnt lgkmcnt(4)
    v_mfma_f32_16x16x32_bf16 v[188:191], a[232:235], a[128:131], v[188:191]
    ds_read_b64_tr_b16 a[224:225], v46 offset:4096
    ds_read_b64_tr_b16 a[226:227], v46 offset:4608
    v_mfma_f32_16x16x32_bf16 v[204:207], a[236:239], a[128:131], v[204:207]
    s_add_u32 s85, s17, 4096
    s_cmp_lt_u32 s85, 28672
    s_cselect_b32 s18, s85, 0
    v_mfma_f32_16x16x32_bf16 v[196:199], a[232:235], a[132:135], v[196:199]
    ds_read_b128 a[144:147], v45 offset:32768
    v_mfma_f32_16x16x32_bf16 v[212:215], a[236:239], a[132:135], v[212:215]
    buffer_load_dwordx4 v9, s[44:47], s71 offen offset:1024  lds
    s_mul_i32 s11, s18, 7
    v_mfma_f32_16x16x32_bf16 v[220:223], a[232:235], a[136:139], v[220:223]
    ds_read_b64_tr_b16 a[228:229], v46 offset:12288
    ds_read_b64_tr_b16 a[230:231], v46 offset:12800
    v_mfma_f32_16x16x32_bf16 v[236:239], a[236:239], a[136:139], v[236:239]
    s_add_u32 s85, s18, 4096
    s_cmp_lt_u32 s85, 28672
    s_cselect_b32 s19, s85, 0
    ds_read_b128 a[148:151], v45 offset:34816
    v_mfma_f32_16x16x32_bf16 v[228:231], a[232:235], a[140:143], v[228:231]
    buffer_load_dwordx4 v10, s[44:47], s71 offen offset:2048  lds
    s_mul_i32 s12, s19, 7
    v_mfma_f32_16x16x32_bf16 v[244:247], a[236:239], a[140:143], v[244:247]
    s_waitcnt lgkmcnt(6)
    ds_read_b128 a[152:155], v45 offset:36864
    v_mfma_f32_16x16x32_bf16 v[192:195], a[240:243], a[128:131], v[192:195]
    ds_read_b128 a[156:159], v45 offset:38912
    v_lshl_add_u32 v178, v172, 4, v178
    v_lshl_add_u32 v178, v175, 9, v178
    v_mfma_f32_16x16x32_bf16 v[208:211], a[244:247], a[128:131], v[208:211]
    ds_read_b64_tr_b16 a[232:233], v47 offset:4096
    buffer_load_dwordx4 v11, s[44:47], s71 offen offset:3072  lds
    v_mfma_f32_16x16x32_bf16 v[200:203], a[240:243], a[132:135], v[200:203]
    v_lshl_add_u32 v178, v180, 10, v178
    v_add_u32 v52, s70, v178
    v_mfma_f32_16x16x32_bf16 v[216:219], a[244:247], a[132:135], v[216:219]
    ds_read_b64_tr_b16 a[234:235], v47 offset:4608
    ds_read_b64_tr_b16 a[236:237], v47 offset:12288
    v_mfma_f32_16x16x32_bf16 v[224:227], a[240:243], a[136:139], v[224:227]
    s_add_u32 s44, s44, 1792
    s_addc_u32 s45, s45, 0
    s_sub_u32 s46, s46, 1792
    v_mfma_f32_16x16x32_bf16 v[240:243], a[244:247], a[136:139], v[240:243]
    s_add_u32 m0, s70, 49152
    s_mul_i32 s71, s77, 1792
    v_mfma_f32_16x16x32_bf16 v[232:235], a[240:243], a[140:143], v[232:235]
    ds_read_b64_tr_b16 a[238:239], v47 offset:12800
    buffer_load_dwordx4 v8, s[44:47], s71 offen offset:0  lds
    v_mfma_f32_16x16x32_bf16 v[248:251], a[244:247], a[140:143], v[248:251]
    v_xor_b32 v54, 64, v52
    s_waitcnt lgkmcnt(4)
    v_mfma_f32_16x16x32_bf16 v[188:191], a[224:227], a[144:147], v[188:191]
    v_mfma_f32_16x16x32_bf16 v[204:207], a[228:231], a[144:147], v[204:207]
    s_waitcnt vmcnt(9) lgkmcnt(0)
    s_barrier
    ds_read_b64_tr_b16 a[240:241], v50 offset:0
    v_mfma_f32_16x16x32_bf16 v[196:199], a[224:227], a[148:151], v[196:199]
    ds_read_b64_tr_b16 a[242:243], v50 offset:512
    v_add_u32 v53, 0x10000, v52
    v_mfma_f32_16x16x32_bf16 v[212:215], a[228:231], a[148:151], v[212:215]
    ds_read_b128 a[160:163], v44 offset:49152
    buffer_load_dwordx4 v9, s[44:47], s71 offen offset:1024  lds
    v_add_u32 v55, 0x10000, v54
    v_mfma_f32_16x16x32_bf16 v[220:223], a[224:227], a[152:155], v[220:223]
    s_mul_i32 s84, s66, 4160
    ds_read_b64_tr_b16 a[244:245], v50 offset:8192
    v_mfma_f32_16x16x32_bf16 v[236:239], a[228:231], a[152:155], v[236:239]
    ds_read_b64_tr_b16 a[246:247], v50 offset:8704
    s_add_u32 s84, s84, 32
    v_lshrrev_b32 v181, 4, v1
    v_mfma_f32_16x16x32_bf16 v[228:231], a[224:227], a[156:159], v[228:231]
    ds_read_b128 a[164:167], v44 offset:51200
    buffer_load_dwordx4 v10, s[44:47], s71 offen offset:2048  lds
    v_mfma_f32_16x16x32_bf16 v[244:247], a[228:231], a[156:159], v[244:247]
    v_lshlrev_b32_e64 v176, 4, v172
    v_lshl_add_u32 v176, v181, 6, v176
    v_mfma_f32_16x16x32_bf16 v[192:195], a[232:235], a[144:147], v[192:195]
    ds_read_b128 a[168:171], v44 offset:53248
    ds_read_b128 a[172:175], v44 offset:55296
    v_mfma_f32_16x16x32_bf16 v[208:211], a[236:239], a[144:147], v[208:211]
    v_lshlrev_b32 v177, 3, v174
    v_sub_u32 v176, v176, v177
    v_mfma_f32_16x16x32_bf16 v[200:203], a[232:235], a[148:151], v[200:203]
    ds_read_b64_tr_b16 a[224:225], v51 offset:0
    buffer_load_dwordx4 v11, s[44:47], s71 offen offset:3072  lds
    v_add_u32 v57, s84, v176
    v_mfma_f32_16x16x32_bf16 v[216:219], a[236:239], a[148:151], v[216:219]
    s_mul_i32 s84, s66, 5056
    ds_read_b64_tr_b16 a[226:227], v51 offset:512
    v_mfma_f32_16x16x32_bf16 v[224:227], a[232:235], a[152:155], v[224:227]
    ds_read_b64_tr_b16 a[228:229], v51 offset:8192
    s_lshl_b32 s85, s67, 8
    v_mfma_f32_16x16x32_bf16 v[240:243], a[236:239], a[152:155], v[240:243]
    s_add_u32 m0, s70, 147456
    s_mul_i32 s71, s78, 1792
    ds_read_b64_tr_b16 a[230:231], v51 offset:8704
    v_mfma_f32_16x16x32_bf16 v[232:235], a[232:235], a[156:159], v[232:235]
    buffer_load_dwordx4 v8, s[44:47], s71 offen offset:0  lds
    s_add_u32 s84, s84, s85
    v_mfma_f32_16x16x32_bf16 v[248:251], a[236:239], a[156:159], v[248:251]
    s_waitcnt lgkmcnt(4)
    ds_read_b64_tr_b16 a[232:233], v50 offset:4096
    v_mfma_f32_16x16x32_bf16 v[188:191], a[240:243], a[160:163], v[188:191]
    ds_read_b64_tr_b16 a[234:235], v50 offset:4608
    s_add_u32 s84, s84, 8512
    v_sub_u32_e64 v177, v172, v181
    v_mfma_f32_16x16x32_bf16 v[204:207], a[244:247], a[160:163], v[204:207]
    ds_read_b128 a[176:179], v45 offset:49152
    buffer_load_dwordx4 v9, s[44:47], s71 offen offset:1024  lds
    v_mfma_f32_16x16x32_bf16 v[196:199], a[240:243], a[164:167], v[196:199]
    v_lshl_add_u32 v177, v177, 6, s84
    v_lshl_add_u32 v58, v174, 4, v177
    v_mfma_f32_16x16x32_bf16 v[212:215], a[244:247], a[164:167], v[212:215]
    ds_read_b64_tr_b16 a[236:237], v50 offset:12288
    ds_read_b64_tr_b16 a[238:239], v50 offset:12800
    v_mfma_f32_16x16x32_bf16 v[220:223], a[240:243], a[168:171], v[220:223]
    v_lshl_add_u32 v176, v172, 2, v181
    v_lshl_add_u32 v176, v174, 6, v176
    v_mfma_f32_16x16x32_bf16 v[236:239], a[244:247], a[168:171], v[236:239]
    ds_read_b128 a[180:183], v45 offset:51200
    v_mfma_f32_16x16x32_bf16 v[228:231], a[240:243], a[172:175], v[228:231]
    buffer_load_dwordx4 v10, s[44:47], s71 offen offset:2048  lds
    s_lshl_b32 s84, s67, 4
    v_mfma_f32_16x16x32_bf16 v[244:247], a[244:247], a[172:175], v[244:247]
    s_waitcnt lgkmcnt(6)
    ds_read_b128 a[184:187], v45 offset:53248
    v_mfma_f32_16x16x32_bf16 v[192:195], a[224:227], a[160:163], v[192:195]
    ds_read_b128 a[188:191], v45 offset:55296
    v_add_u32_e64 v59, s84, v176
    v_mfma_f32_16x16x32_bf16 v[208:211], a[228:231], a[160:163], v[208:211]
    s_lshl1_add_u32 s84, s62, s66
    ds_read_b64_tr_b16 a[240:241], v51 offset:4096
    v_mfma_f32_16x16x32_bf16 v[200:203], a[224:227], a[164:167], v[200:203]
    buffer_load_dwordx4 v11, s[44:47], s71 offen offset:3072  lds
    s_mul_i32 s85, s84, 14
    v_mfma_f32_16x16x32_bf16 v[216:219], a[228:231], a[164:167], v[216:219]
    s_add_u32 s85, s85, s63
    ds_read_b64_tr_b16 a[242:243], v51 offset:4608
    v_mfma_f32_16x16x32_bf16 v[224:227], a[224:227], a[168:171], v[224:227]
    ds_read_b64_tr_b16 a[244:245], v51 offset:12288
    s_lshl1_add_u32 s85, s85, s67
    v_mfma_f32_16x16x32_bf16 v[240:243], a[228:231], a[168:171], v[240:243]
    s_add_u32 m0, s70, 65536
    s_mul_i32 s71, s79, 1792
    v_mfma_f32_16x16x32_bf16 v[232:235], a[224:227], a[172:175], v[232:235]
    ds_read_b64_tr_b16 a[246:247], v51 offset:12800
    buffer_load_dwordx4 v8, s[44:47], s71 offen offset:0  lds
    v_mfma_f32_16x16x32_bf16 v[248:251], a[228:231], a[172:175], v[248:251]
    s_mul_i32 s84, s84, 28
    s_waitcnt lgkmcnt(4)
    v_mfma_f32_16x16x32_bf16 v[188:191], a[232:235], a[176:179], v[188:191]
    v_mfma_f32_16x16x32_bf16 v[204:207], a[236:239], a[176:179], v[204:207]
    s_waitcnt vmcnt(9) lgkmcnt(0)
    s_barrier
    v_mfma_f32_16x16x32_bf16 v[196:199], a[232:235], a[180:183], v[196:199]
    ds_read_b64_tr_b16 a[224:225], v50 offset:32768
    ds_read_b64_tr_b16 a[226:227], v50 offset:33280
    v_mfma_f32_16x16x32_bf16 v[212:215], a[236:239], a[180:183], v[212:215]
    s_add_u32 s75, s84, s85
    ds_read_b128 a[192:195], v48 offset:16384
    v_mfma_f32_16x16x32_bf16 v[220:223], a[232:235], a[184:187], v[220:223]
    buffer_load_dwordx4 v9, s[44:47], s71 offen offset:1024  lds
    s_lshl_b32 s75, s75, 12
    v_mfma_f32_16x16x32_bf16 v[236:239], a[236:239], a[184:187], v[236:239]
    s_add_u32 s76, s75, 114688
    ds_read_b64_tr_b16 a[228:229], v50 offset:40960
    v_mfma_f32_16x16x32_bf16 v[228:231], a[232:235], a[188:191], v[228:231]
    ds_read_b64_tr_b16 a[230:231], v50 offset:41472
    s_lshl_b32 s85, s85, 7
    v_mfma_f32_16x16x32_bf16 v[244:247], a[236:239], a[188:191], v[244:247]
    s_add_u32 s85, s85, 13631488
    ds_read_b128 a[196:199], v48 offset:18432
    v_mfma_f32_16x16x32_bf16 v[192:195], a[240:243], a[176:179], v[192:195]
    buffer_load_dwordx4 v10, s[44:47], s71 offen offset:2048  lds
    v_and_b32 v176, 31, v1
    v_lshlrev_b32_e64 v60, 2, v176
    v_mfma_f32_16x16x32_bf16 v[208:211], a[244:247], a[176:179], v[208:211]
    ds_read_b128 a[200:203], v48 offset:20480
    ds_read_b128 a[204:207], v48 offset:22528
    v_add_u32 v61, s85, v60
    v_mfma_f32_16x16x32_bf16 v[200:203], a[240:243], a[180:183], v[200:203]
    s_lshl1_add_u32 s84, s65, s66
    ds_read_b64_tr_b16 a[232:233], v51 offset:32768
    v_mfma_f32_16x16x32_bf16 v[216:219], a[244:247], a[180:183], v[216:219]
    buffer_load_dwordx4 v11, s[44:47], s71 offen offset:3072  lds
    s_lshl_b32 s84, s84, 5
    v_add_u32 v64, s84, v176
    v_mfma_f32_16x16x32_bf16 v[224:227], a[240:243], a[184:187], v[224:227]
    ds_read_b64_tr_b16 a[234:235], v51 offset:33280
    ds_read_b64_tr_b16 a[236:237], v51 offset:40960
    v_mfma_f32_16x16x32_bf16 v[240:243], a[244:247], a[184:187], v[240:243]
    s_add_u32 m0, s70, 32768
    s_mul_i32 s71, s80, 1792
    ds_read_b64_tr_b16 a[238:239], v51 offset:41472
    v_mfma_f32_16x16x32_bf16 v[232:235], a[240:243], a[188:191], v[232:235]
    buffer_load_dwordx4 v8, s[44:47], s71 offen offset:0  lds
    v_cmp_lt_u32 s[86:87], 55, v1
    v_mfma_f32_16x16x32_bf16 v[248:251], a[244:247], a[188:191], v[248:251]
    s_mul_i32 s84, s65, 28
    s_waitcnt lgkmcnt(4)
    ds_read_b64_tr_b16 a[240:241], v50 offset:36864
    v_mfma_f32_16x16x32_bf16 v[188:191], a[224:227], a[192:195], v[188:191]
    ds_read_b64_tr_b16 a[242:243], v50 offset:37376
    s_add_u32 s85, s84, s21
    v_mfma_f32_16x16x32_bf16 v[204:207], a[228:231], a[192:195], v[204:207]
    s_add_u32 s84, s84, s85
    ds_read_b128 a[208:211], v49 offset:16384
    v_mfma_f32_16x16x32_bf16 v[196:199], a[224:227], a[196:199], v[196:199]
    buffer_load_dwordx4 v9, s[44:47], s71 offen offset:1024  lds
    s_lshl_b32 s85, s85, 7
    v_mfma_f32_16x16x32_bf16 v[212:215], a[228:231], a[196:199], v[212:215]
    ds_read_b64_tr_b16 a[244:245], v50 offset:45056
    ds_read_b64_tr_b16 a[246:247], v50 offset:45568
    v_mfma_f32_16x16x32_bf16 v[220:223], a[224:227], a[200:203], v[220:223]
    s_add_u32 s85, s85, 13631488
    v_min_u32 v176, 6, v173
    v_mfma_f32_16x16x32_bf16 v[236:239], a[228:231], a[200:203], v[236:239]
    ds_read_b128 a[212:215], v49 offset:18432
    buffer_load_dwordx4 v10, s[44:47], s71 offen offset:2048  lds
    v_mfma_f32_16x16x32_bf16 v[228:231], a[224:227], a[204:207], v[228:231]
    v_lshl_add_u32 v62, v176, 7, s85
    v_add_u32 v63, 114688, v62
    v_mfma_f32_16x16x32_bf16 v[244:247], a[228:231], a[204:207], v[244:247]
    s_waitcnt lgkmcnt(6)
    ds_read_b128 a[216:219], v49 offset:20480
    v_mfma_f32_16x16x32_bf16 v[192:195], a[232:235], a[192:195], v[192:195]
    ds_read_b128 a[220:223], v49 offset:22528
    s_lshl_b32 s85, s65, 8
    v_mfma_f32_16x16x32_bf16 v[208:211], a[236:239], a[192:195], v[208:211]
    s_add_u32 s85, s85, 13860864
    ds_read_b64_tr_b16 a[224:225], v51 offset:36864
    v_mfma_f32_16x16x32_bf16 v[200:203], a[232:235], a[196:199], v[200:203]
    buffer_load_dwordx4 v11, s[44:47], s71 offen offset:3072  lds
    v_mfma_f32_16x16x32_bf16 v[216:219], a[236:239], a[196:199], v[216:219]
    v_mov_b32_e64 v177, s85
    v_cndmask_b32 v63, v63, v177, s[86:87]
    v_mfma_f32_16x16x32_bf16 v[224:227], a[232:235], a[200:203], v[224:227]
    ds_read_b64_tr_b16 a[226:227], v51 offset:37376
    ds_read_b64_tr_b16 a[228:229], v51 offset:45056
    v_mfma_f32_16x16x32_bf16 v[240:243], a[236:239], a[200:203], v[240:243]
    s_add_u32 m0, s70, 81920
    s_mul_i32 s71, s81, 1792
    ds_read_b64_tr_b16 a[230:231], v51 offset:45568
    v_mfma_f32_16x16x32_bf16 v[232:235], a[232:235], a[204:207], v[232:235]
    buffer_load_dwordx4 v8, s[44:47], s71 offen offset:0  lds
    s_lshl_b32 s84, s84, 12
    v_mfma_f32_16x16x32_bf16 v[248:251], a[236:239], a[204:207], v[248:251]
    s_lshl_b32 s85, s66, 11
    s_waitcnt lgkmcnt(4)
    v_mfma_f32_16x16x32_bf16 v[188:191], a[240:243], a[208:211], v[188:191]
    v_mfma_f32_16x16x32_bf16 v[204:207], a[244:247], a[208:211], v[204:207]
    s_waitcnt vmcnt(9) lgkmcnt(0)
    s_barrier
    v_mfma_f32_16x16x32_bf16 v[196:199], a[240:243], a[212:215], v[196:199]
    ds_read_b64_tr_b16 a[232:233], v46 offset:16384
    ds_read_b64_tr_b16 a[234:235], v46 offset:16896
    v_mfma_f32_16x16x32_bf16 v[212:215], a[244:247], a[212:215], v[212:215]
    buffer_load_dwordx4 v9, s[44:47], s71 offen offset:1024  lds
    s_add_u32 s85, s85, s84
    v_mfma_f32_16x16x32_bf16 v[220:223], a[240:243], a[216:219], v[220:223]
    v_add_u32_e64 v70, s85, v2
    v_xor_b32 v71, 0x800, v70
    v_mfma_f32_16x16x32_bf16 v[236:239], a[244:247], a[216:219], v[236:239]
    ds_read_b64_tr_b16 a[236:237], v46 offset:24576
    ds_read_b64_tr_b16 a[238:239], v46 offset:25088
    v_mfma_f32_16x16x32_bf16 v[228:231], a[240:243], a[220:223], v[228:231]
    global_load_dword v3, v60, s[34:35] sc1
    v_mfma_f32_16x16x32_bf16 v[244:247], a[244:247], a[220:223], v[244:247]
    buffer_load_dwordx4 v10, s[44:47], s71 offen offset:2048  lds
    v_mfma_f32_16x16x32_bf16 v[192:195], a[224:227], a[208:211], v[192:195]
    ds_read_b64_tr_b16 a[240:241], v47 offset:16384
    v_mfma_f32_16x16x32_bf16 v[208:211], a[228:231], a[208:211], v[208:211]
    ds_read_b64_tr_b16 a[242:243], v47 offset:16896
    v_mfma_f32_16x16x32_bf16 v[200:203], a[224:227], a[212:215], v[200:203]
    buffer_load_dwordx4 v11, s[44:47], s71 offen offset:3072  lds
    v_mfma_f32_16x16x32_bf16 v[216:219], a[228:231], a[212:215], v[216:219]
    ds_read_b64_tr_b16 a[244:245], v47 offset:24576
    v_mfma_f32_16x16x32_bf16 v[224:227], a[224:227], a[216:219], v[224:227]
    ds_read_b64_tr_b16 a[246:247], v47 offset:25088
    v_mfma_f32_16x16x32_bf16 v[240:243], a[228:231], a[216:219], v[240:243]
    s_add_u32 m0, s70, 98304
    s_mul_i32 s71, s82, 1792
    v_mfma_f32_16x16x32_bf16 v[232:235], a[224:227], a[220:223], v[232:235]
    buffer_load_dwordx4 v8, s[44:47], s71 offen offset:0  lds
    s_waitcnt lgkmcnt(4)
    v_mfma_f32_16x16x32_bf16 v[248:251], a[228:231], a[220:223], v[248:251]
    ds_read_b64_tr_b16 a[224:225], v46 offset:20480
    ds_read_b64_tr_b16 a[226:227], v46 offset:20992
    v_mfma_f32_16x16x32_bf16 v[76:79], a[232:235], a[0:3], 0
    buffer_load_dwordx4 v9, s[44:47], s71 offen offset:1024  lds
    v_mul_f32 v172, v188, v188
    v_mfma_f32_16x16x32_bf16 v[92:95], a[236:239], a[0:3], 0
    v_mul_f32 v173, v189, v189
    v_mul_f32 v174, v190, v190
    v_mfma_f32_16x16x32_bf16 v[84:87], a[232:235], a[4:7], 0
    v_mul_f32_e64 v175, v191, v191
    v_fma_f32 v172, v172, v66, v68
    v_fma_f32 v173, v173, v66, v68
    v_mfma_f32_16x16x32_bf16 v[100:103], a[236:239], a[4:7], 0
    ds_read_b64_tr_b16 a[228:229], v46 offset:28672
    ds_read_b64_tr_b16 a[230:231], v46 offset:29184
    v_fma_f32 v174, v174, v66, v68
    v_mfma_f32_16x16x32_bf16 v[108:111], a[232:235], a[8:11], 0
    v_fma_f32 v175, v175, v66, v68
    v_mul_f32 v172, v188, v172
    v_mul_f32 v173, v189, v173
    v_mfma_f32_16x16x32_bf16 v[124:127], a[236:239], a[8:11], 0
L_pad2:
    s_cbranch_execz L_ret
    s_nop 0
    buffer_load_dwordx4 v10, s[44:47], s71 offen offset:2048  lds
    v_mul_f32 v174, v190, v174
    v_mul_f32 v175, v191, v175
    v_mfma_f32_16x16x32_bf16 v[116:119], a[232:235], a[12:15], 0
    v_exp_f32_e64 v172, v172
    v_mul_f32 v204, v188, v204
    v_mfma_f32_16x16x32_bf16 v[132:135], a[236:239], a[12:15], 0
    s_waitcnt lgkmcnt(4)
    ds_read_b64_tr_b16 a[232:233], v47 offset:20480
    v_mfma_f32_16x16x32_bf16 v[80:83], a[240:243], a[0:3], 0
    ds_read_b64_tr_b16 a[234:235], v47 offset:20992
    v_exp_f32 v173, v173
    v_mul_f32 v205, v189, v205
    v_mfma_f32_16x16x32_bf16 v[96:99], a[244:247], a[0:3], 0
    buffer_load_dwordx4 v11, s[44:47], s71 offen offset:3072  lds
    v_exp_f32_e64 v174, v174
    v_mfma_f32_16x16x32_bf16 v[88:91], a[240:243], a[4:7], 0
    v_mul_f32 v206, v190, v206
    v_exp_f32 v175, v175
    v_mfma_f32_16x16x32_bf16 v[104:107], a[244:247], a[4:7], 0
    v_mul_f32 v207, v191, v207
    v_add_f32 v172, 1.0, v172
    v_mfma_f32_16x16x32_bf16 v[112:115], a[240:243], a[8:11], 0
    ds_read_b64_tr_b16 a[236:237], v47 offset:28672
    ds_read_b64_tr_b16 a[238:239], v47 offset:29184
    v_add_f32 v173, 1.0, v173
    v_add_f32 v174, 1.0, v174
    v_mfma_f32_16x16x32_bf16 v[128:131], a[244:247], a[8:11], 0
    s_add_u32 m0, s70, 114688
    s_mul_i32 s71, s83, 1792
    buffer_load_dwordx4 v8, s[44:47], s71 offen offset:0  lds
    v_add_f32_e64 v175, 1.0, v175
    v_mfma_f32_16x16x32_bf16 v[120:123], a[240:243], a[12:15], 0
    v_rcp_f32_e64 v172, v172
    v_rcp_f32 v173, v173
    v_mfma_f32_16x16x32_bf16 v[136:139], a[244:247], a[12:15], 0
    s_waitcnt lgkmcnt(4)
    ds_read_b64_tr_b16 a[240:241], v50 offset:49152
    v_mfma_f32_16x16x32_bf16 v[76:79], a[224:227], a[16:19], v[76:79]
    ds_read_b64_tr_b16 a[242:243], v50 offset:49664
    v_rcp_f32_e64 v174, v174
    v_mfma_f32_16x16x32_bf16 v[92:95], a[228:231], a[16:19], v[92:95]
    v_rcp_f32_e64 v175, v175
    v_mfma_f32_16x16x32_bf16 v[84:87], a[224:227], a[20:23], v[84:87]
    buffer_load_dwordx4 v9, s[44:47], s71 offen offset:1024  lds
    v_mul_f32 v204, v204, v172
    v_mul_f32 v205, v205, v173
    v_mfma_f32_16x16x32_bf16 v[100:103], a[228:231], a[20:23], v[100:103]
    v_mul_f32 v206, v206, v174
    v_mul_f32 v207, v207, v175
    v_cvt_pk_bf16_f32 v140, v204, v205
    v_cvt_pk_bf16_f32 v141, v206, v207
    v_mfma_f32_16x16x32_bf16 v[108:111], a[224:227], a[24:27], v[108:111]
    ds_read_b64_tr_b16 a[244:245], v50 offset:57344
    ds_read_b64_tr_b16 a[246:247], v50 offset:57856
    v_mul_f32_e64 v176, v192, v192
    v_mfma_f32_16x16x32_bf16 v[124:127], a[228:231], a[24:27], v[124:127]
    v_mul_f32 v177, v193, v193
    v_mul_f32 v178, v194, v194
    v_mul_f32_e64 v179, v195, v195
    v_fma_f32 v176, v176, v66, v68
    v_mfma_f32_16x16x32_bf16 v[116:119], a[224:227], a[28:31], v[116:119]
    buffer_load_dwordx4 v10, s[44:47], s71 offen offset:2048  lds
    v_fma_f32 v177, v177, v66, v68
    v_fma_f32 v178, v178, v66, v68
    v_fma_f32 v179, v179, v66, v68
    v_mul_f32 v176, v192, v176
    v_mfma_f32_16x16x32_bf16 v[132:135], a[228:231], a[28:31], v[132:135]
    s_waitcnt lgkmcnt(4)
    ds_read_b64_tr_b16 a[224:225], v51 offset:49152
    v_mfma_f32_16x16x32_bf16 v[80:83], a[232:235], a[16:19], v[80:83]
    ds_read_b64_tr_b16 a[226:227], v51 offset:49664
    v_mul_f32 v177, v193, v177
    v_mul_f32 v178, v194, v178
    v_mfma_f32_16x16x32_bf16 v[96:99], a[236:239], a[16:19], v[96:99]
    v_mul_f32 v179, v195, v179
    v_exp_f32 v176, v176
    v_mfma_f32_16x16x32_bf16 v[88:91], a[232:235], a[20:23], v[88:91]
    buffer_load_dwordx4 v11, s[44:47], s71 offen offset:3072  lds
    v_mul_f32 v208, v192, v208
    v_exp_f32 v177, v177
    v_mul_f32_e64 v209, v193, v209
    v_mfma_f32_16x16x32_bf16 v[104:107], a[236:239], a[20:23], v[104:107]
    ds_read_b64_tr_b16 a[228:229], v51 offset:57344
    ds_read_b64_tr_b16 a[230:231], v51 offset:57856
    v_exp_f32_e64 v178, v178
    v_mfma_f32_16x16x32_bf16 v[112:115], a[232:235], a[24:27], v[112:115]
    v_mul_f32 v210, v194, v210
    v_exp_f32 v179, v179
    v_mfma_f32_16x16x32_bf16 v[128:131], a[236:239], a[24:27], v[128:131]
    s_add_u32 m0, s70, 131072
    s_nop 0
    buffer_load_dwordx4 v12, s[48:51], s6 offen offset:0  lds
    v_mul_f32 v211, v195, v211
    v_mfma_f32_16x16x32_bf16 v[120:123], a[232:235], a[28:31], v[120:123]
    v_add_f32 v176, 1.0, v176
    v_add_f32 v177, 1.0, v177
    v_add_f32 v178, 1.0, v178
    v_mfma_f32_16x16x32_bf16 v[136:139], a[236:239], a[28:31], v[136:139]
    s_waitcnt lgkmcnt(4)
    ds_read_b64_tr_b16 a[232:233], v50 offset:53248
    v_mfma_f32_16x16x32_bf16 v[76:79], a[240:243], a[32:35], v[76:79]
    ds_read_b64_tr_b16 a[234:235], v50 offset:53760
    v_add_f32_e64 v179, 1.0, v179
    v_mfma_f32_16x16x32_bf16 v[92:95], a[244:247], a[32:35], v[92:95]
    v_rcp_f32 v176, v176
    v_rcp_f32 v177, v177
    v_mfma_f32_16x16x32_bf16 v[84:87], a[240:243], a[36:39], v[84:87]
    buffer_load_dwordx4 v13, s[48:51], s6 offen offset:1024  lds
    v_rcp_f32_e64 v178, v178
    v_mfma_f32_16x16x32_bf16 v[100:103], a[244:247], a[36:39], v[100:103]
    v_rcp_f32 v179, v179
    v_mul_f32 v208, v208, v176
    v_mfma_f32_16x16x32_bf16 v[108:111], a[240:243], a[40:43], v[108:111]
    ds_read_b64_tr_b16 a[236:237], v50 offset:61440
    ds_read_b64_tr_b16 a[238:239], v50 offset:61952
    v_mul_f32_e64 v209, v209, v177
    v_mfma_f32_16x16x32_bf16 v[124:127], a[244:247], a[40:43], v[124:127]
    v_mul_f32 v210, v210, v178
    v_mul_f32 v211, v211, v179
    v_cvt_pk_bf16_f32 v142, v208, v209
    v_cvt_pk_bf16_f32 v143, v210, v211
    v_mfma_f32_16x16x32_bf16 v[116:119], a[240:243], a[44:47], v[116:119]
    buffer_store_dwordx4 v[140:143], v2, s[52:55], s75 offen offset:0 sc1
    v_mul_f32 v180, v196, v196
    v_mul_f32 v181, v197, v197
    v_mul_f32 v182, v198, v198
    v_mfma_f32_16x16x32_bf16 v[132:135], a[244:247], a[44:47], v[132:135]
    s_waitcnt lgkmcnt(4)
    ds_read_b64_tr_b16 a[240:241], v51 offset:53248
    v_mfma_f32_16x16x32_bf16 v[80:83], a[224:227], a[32:35], v[80:83]
    ds_read_b64_tr_b16 a[242:243], v51 offset:53760
    v_mul_f32_e64 v183, v199, v199
    v_mfma_f32_16x16x32_bf16 v[96:99], a[228:231], a[32:35], v[96:99]
    v_fma_f32 v180, v180, v66, v68
    v_fma_f32 v181, v181, v66, v68
    v_fma_f32 v182, v182, v66, v68
    v_mfma_f32_16x16x32_bf16 v[88:91], a[224:227], a[36:39], v[88:91]
    buffer_load_dwordx4 v14, s[48:51], s6 offen offset:2048  lds
    v_fma_f32 v183, v183, v66, v68
    v_mul_f32_e64 v180, v196, v180
    v_mfma_f32_16x16x32_bf16 v[104:107], a[228:231], a[36:39], v[104:107]
    v_mul_f32 v181, v197, v181
    v_mul_f32 v182, v198, v182
    v_mul_f32_e64 v183, v199, v183
    v_mfma_f32_16x16x32_bf16 v[112:115], a[224:227], a[40:43], v[112:115]
    ds_read_b64_tr_b16 a[244:245], v51 offset:61440
    ds_read_b64_tr_b16 a[246:247], v51 offset:61952
    v_exp_f32_e64 v180, v180
    v_mfma_f32_16x16x32_bf16 v[128:131], a[228:231], a[40:43], v[128:131]
    v_mul_f32 v212, v196, v212
    v_exp_f32 v181, v181
    v_mfma_f32_16x16x32_bf16 v[120:123], a[224:227], a[44:47], v[120:123]
    buffer_load_dwordx4 v15, s[48:51], s6 offen offset:3072  lds
    v_mul_f32_e64 v213, v197, v213
    v_mfma_f32_16x16x32_bf16 v[136:139], a[228:231], a[44:47], v[136:139]
    v_exp_f32_e64 v182, v182
    v_mul_f32 v214, v198, v214
    s_waitcnt lgkmcnt(4)
    v_mfma_f32_16x16x32_bf16 v[76:79], a[232:235], a[48:51], v[76:79]
    v_mfma_f32_16x16x32_bf16 v[92:95], a[236:239], a[48:51], v[92:95]
    s_waitcnt vmcnt(18) lgkmcnt(0)
    s_barrier
    ds_read_b64_tr_b16 a[224:225], v46 offset:32768
    v_mfma_f32_16x16x32_bf16 v[84:87], a[232:235], a[52:55], v[84:87]
    ds_read_b64_tr_b16 a[226:227], v46 offset:33280
    s_add_u32 m0, s70, 49152
    v_mfma_f32_16x16x32_bf16 v[100:103], a[236:239], a[52:55], v[100:103]
    buffer_load_dwordx4 v12, s[48:51], s7 offen offset:0  lds
    v_exp_f32 v183, v183
    v_mul_f32 v215, v199, v215
    v_mfma_f32_16x16x32_bf16 v[108:111], a[232:235], a[56:59], v[108:111]
    v_add_f32 v180, 1.0, v180
    v_add_f32 v181, 1.0, v181
    v_add_f32_e64 v182, 1.0, v182
    v_mfma_f32_16x16x32_bf16 v[124:127], a[236:239], a[56:59], v[124:127]
    ds_read_b64_tr_b16 a[228:229], v46 offset:40960
    ds_read_b64_tr_b16 a[230:231], v46 offset:41472
    v_add_f32 v183, 1.0, v183
    v_rcp_f32 v180, v180
    v_mfma_f32_16x16x32_bf16 v[116:119], a[232:235], a[60:63], v[116:119]
    buffer_load_dwordx4 v13, s[48:51], s7 offen offset:1024  lds
    v_rcp_f32_e64 v181, v181
    v_mfma_f32_16x16x32_bf16 v[132:135], a[236:239], a[60:63], v[132:135]
    v_rcp_f32 v182, v182
    v_rcp_f32 v183, v183
    v_mfma_f32_16x16x32_bf16 v[80:83], a[240:243], a[48:51], v[80:83]
    ds_read_b64_tr_b16 a[232:233], v47 offset:32768
    ds_read_b64_tr_b16 a[234:235], v47 offset:33280
    v_mul_f32_e64 v212, v212, v180
    v_mfma_f32_16x16x32_bf16 v[96:99], a[244:247], a[48:51], v[96:99]
    v_mul_f32 v213, v213, v181
    v_mul_f32 v214, v214, v182
    v_mul_f32_e64 v215, v215, v183
    v_mfma_f32_16x16x32_bf16 v[88:91], a[240:243], a[52:55], v[88:91]
    buffer_load_dwordx4 v14, s[48:51], s7 offen offset:2048  lds
    v_cvt_pk_bf16_f32 v144, v212, v213
    v_cvt_pk_bf16_f32 v145, v214, v215
    v_mfma_f32_16x16x32_bf16 v[104:107], a[244:247], a[52:55], v[104:107]
    v_mul_f32 v184, v200, v200
    v_mul_f32 v185, v201, v201
    v_mul_f32 v186, v202, v202
    v_mul_f32 v187, v203, v203
    v_mfma_f32_16x16x32_bf16 v[112:115], a[240:243], a[56:59], v[112:115]
    ds_read_b64_tr_b16 a[236:237], v47 offset:40960
    ds_read_b64_tr_b16 a[238:239], v47 offset:41472
    v_fma_f32 v184, v184, v66, v68
    v_mfma_f32_16x16x32_bf16 v[128:131], a[244:247], a[56:59], v[128:131]
    v_fma_f32 v185, v185, v66, v68
    v_fma_f32 v186, v186, v66, v68
    v_fma_f32 v187, v187, v66, v68
    v_mfma_f32_16x16x32_bf16 v[120:123], a[240:243], a[60:63], v[120:123]
    buffer_load_dwordx4 v15, s[48:51], s7 offen offset:3072  lds
    v_mul_f32 v184, v200, v184
    v_mul_f32 v185, v201, v185
    v_mul_f32_e64 v186, v202, v186
    v_mul_f32 v187, v203, v187
    v_mfma_f32_16x16x32_bf16 v[136:139], a[244:247], a[60:63], v[136:139]
    s_waitcnt lgkmcnt(4)
    ds_read_b64_tr_b16 a[240:241], v46 offset:36864
    v_mfma_f32_16x16x32_bf16 v[76:79], a[224:227], a[64:67], v[76:79]
    ds_read_b64_tr_b16 a[242:243], v46 offset:37376
    v_exp_f32 v184, v184
    v_mul_f32 v216, v200, v216
    v_mfma_f32_16x16x32_bf16 v[92:95], a[228:231], a[64:67], v[92:95]
    s_add_u32 m0, s70, 147456
    s_nop 0
    buffer_load_dwordx4 v12, s[48:51], s8 offen offset:0  lds
    v_exp_f32 v185, v185
    v_mfma_f32_16x16x32_bf16 v[84:87], a[224:227], a[68:71], v[84:87]
    v_mul_f32 v217, v201, v217
    v_exp_f32 v186, v186
    v_mfma_f32_16x16x32_bf16 v[100:103], a[228:231], a[68:71], v[100:103]
    ds_read_b64_tr_b16 a[244:245], v46 offset:45056
    ds_read_b64_tr_b16 a[246:247], v46 offset:45568
    v_mul_f32_e64 v218, v202, v218
    v_mfma_f32_16x16x32_bf16 v[108:111], a[224:227], a[72:75], v[108:111]
    v_exp_f32 v187, v187
    v_mul_f32 v219, v203, v219
    v_mfma_f32_16x16x32_bf16 v[124:127], a[228:231], a[72:75], v[124:127]
    buffer_load_dwordx4 v13, s[48:51], s8 offen offset:1024  lds
    v_add_f32_e64 v184, 1.0, v184
    v_mfma_f32_16x16x32_bf16 v[116:119], a[224:227], a[76:79], v[116:119]
    v_add_f32 v185, 1.0, v185
    v_add_f32 v186, 1.0, v186
    v_add_f32 v187, 1.0, v187
    v_mfma_f32_16x16x32_bf16 v[132:135], a[228:231], a[76:79], v[132:135]
    s_waitcnt lgkmcnt(4)
    ds_read_b64_tr_b16 a[224:225], v47 offset:36864
    v_mfma_f32_16x16x32_bf16 v[80:83], a[232:235], a[64:67], v[80:83]
    ds_read_b64_tr_b16 a[226:227], v47 offset:37376
    v_rcp_f32_e64 v184, v184
    v_mfma_f32_16x16x32_bf16 v[96:99], a[236:239], a[64:67], v[96:99]
    v_rcp_f32_e64 v185, v185
    v_mfma_f32_16x16x32_bf16 v[88:91], a[232:235], a[68:71], v[88:91]
    buffer_load_dwordx4 v14, s[48:51], s8 offen offset:2048  lds
    v_rcp_f32_e64 v186, v186
    v_mfma_f32_16x16x32_bf16 v[104:107], a[236:239], a[68:71], v[104:107]
    v_rcp_f32 v187, v187
    v_mul_f32 v216, v216, v184
    v_mul_f32_e64 v217, v217, v185
    v_mfma_f32_16x16x32_bf16 v[112:115], a[232:235], a[72:75], v[112:115]
    ds_read_b64_tr_b16 a[228:229], v47 offset:45056
    ds_read_b64_tr_b16 a[230:231], v47 offset:45568
    v_mul_f32_e64 v218, v218, v186
    v_mfma_f32_16x16x32_bf16 v[128:131], a[236:239], a[72:75], v[128:131]
    v_mul_f32_e64 v219, v219, v187
    v_cvt_pk_bf16_f32 v146, v216, v217
    v_cvt_pk_bf16_f32 v147, v218, v219
    v_mfma_f32_16x16x32_bf16 v[120:123], a[232:235], a[76:79], v[120:123]
    buffer_store_dwordx4 v[144:147], v2, s[52:55], s75 offen offset:1024 sc1
    v_mul_f32 v172, v220, v220
    v_mul_f32 v173, v221, v221
    v_mul_f32 v174, v222, v222
    v_mfma_f32_16x16x32_bf16 v[136:139], a[236:239], a[76:79], v[136:139]
    s_waitcnt lgkmcnt(4)
    ds_read_b64_tr_b16 a[232:233], v46 offset:0
    v_mfma_f32_16x16x32_bf16 v[76:79], a[240:243], a[80:83], v[76:79]
    ds_read_b64_tr_b16 a[234:235], v46 offset:512
    v_mul_f32_e64 v175, v223, v223
    v_mfma_f32_16x16x32_bf16 v[92:95], a[244:247], a[80:83], v[92:95]
    v_fma_f32 v172, v172, v66, v68
    v_fma_f32 v173, v173, v66, v68
    v_fma_f32 v174, v174, v66, v68
    v_mfma_f32_16x16x32_bf16 v[84:87], a[240:243], a[84:87], v[84:87]
    buffer_load_dwordx4 v15, s[48:51], s8 offen offset:3072  lds
    v_fma_f32 v175, v175, v66, v68
    v_mul_f32_e64 v172, v220, v172
    v_mfma_f32_16x16x32_bf16 v[100:103], a[244:247], a[84:87], v[100:103]
    v_mul_f32 v173, v221, v173
    v_mul_f32 v174, v222, v174
    v_mul_f32_e64 v175, v223, v175
    v_mfma_f32_16x16x32_bf16 v[108:111], a[240:243], a[88:91], v[108:111]
    ds_read_b64_tr_b16 a[236:237], v46 offset:8192
    ds_read_b64_tr_b16 a[238:239], v46 offset:8704
    v_exp_f32_e64 v172, v172
    v_mfma_f32_16x16x32_bf16 v[124:127], a[244:247], a[88:91], v[124:127]
    v_mul_f32 v236, v220, v236
    v_exp_f32 v173, v173
    v_mfma_f32_16x16x32_bf16 v[116:119], a[240:243], a[92:95], v[116:119]
    v_mul_f32 v237, v221, v237
    v_exp_f32 v174, v174
    v_mul_f32 v238, v222, v238
    v_mfma_f32_16x16x32_bf16 v[132:135], a[244:247], a[92:95], v[132:135]
    s_waitcnt lgkmcnt(4)
    ds_read_b64_tr_b16 a[240:241], v47 offset:0
    v_mfma_f32_16x16x32_bf16 v[80:83], a[224:227], a[80:83], v[80:83]
    ds_read_b64_tr_b16 a[242:243], v47 offset:512
    v_exp_f32_e64 v175, v175
    v_mfma_f32_16x16x32_bf16 v[96:99], a[228:231], a[80:83], v[96:99]
    v_mul_f32 v239, v223, v239
    v_add_f32 v172, 1.0, v172
    v_add_f32_e64 v173, 1.0, v173
    v_mfma_f32_16x16x32_bf16 v[88:91], a[224:227], a[84:87], v[88:91]
    v_add_f32 v174, 1.0, v174
    v_add_f32 v175, 1.0, v175
    v_mfma_f32_16x16x32_bf16 v[104:107], a[228:231], a[84:87], v[104:107]
    v_rcp_f32 v172, v172
    v_rcp_f32 v173, v173
    v_mfma_f32_16x16x32_bf16 v[112:115], a[224:227], a[88:91], v[112:115]
    ds_read_b64_tr_b16 a[244:245], v47 offset:8192
    ds_read_b64_tr_b16 a[246:247], v47 offset:8704
    v_rcp_f32_e64 v174, v174
    v_mfma_f32_16x16x32_bf16 v[128:131], a[228:231], a[88:91], v[128:131]
    v_rcp_f32 v175, v175
    v_mul_f32 v236, v236, v172
    v_mul_f32_e64 v237, v237, v173
    v_mfma_f32_16x16x32_bf16 v[120:123], a[224:227], a[92:95], v[120:123]
    v_mul_f32 v238, v238, v174
    v_mul_f32 v239, v239, v175
    v_cvt_pk_bf16_f32 v148, v236, v237
    v_cvt_pk_bf16_f32 v149, v238, v239
    v_mfma_f32_16x16x32_bf16 v[136:139], a[228:231], a[92:95], v[136:139]
    s_waitcnt lgkmcnt(4)
    ds_read_b64_tr_b16 a[224:225], v46 offset:4096
    v_mfma_f32_16x16x32_bf16 v[76:79], a[232:235], a[96:99], v[76:79]
    ds_read_b64_tr_b16 a[226:227], v46 offset:4608
    v_mul_f32 v176, v224, v224
    v_mul_f32_e64 v177, v225, v225
    v_mfma_f32_16x16x32_bf16 v[92:95], a[236:239], a[96:99], v[92:95]
    v_mul_f32 v178, v226, v226
    v_mul_f32 v179, v227, v227
    v_fma_f32 v176, v176, v66, v68
    v_fma_f32 v177, v177, v66, v68
    v_mfma_f32_16x16x32_bf16 v[84:87], a[232:235], a[100:103], v[84:87]
    v_fma_f32 v178, v178, v66, v68
    v_fma_f32 v179, v179, v66, v68
    v_mul_f32 v176, v224, v176
    v_mul_f32 v177, v225, v177
    v_mfma_f32_16x16x32_bf16 v[100:103], a[236:239], a[100:103], v[100:103]
    ds_read_b64_tr_b16 a[228:229], v46 offset:12288
    ds_read_b64_tr_b16 a[230:231], v46 offset:12800
    v_mul_f32_e64 v178, v226, v178
    v_mfma_f32_16x16x32_bf16 v[108:111], a[232:235], a[104:107], v[108:111]
    v_mul_f32 v179, v227, v179
    v_exp_f32 v176, v176
    v_mfma_f32_16x16x32_bf16 v[124:127], a[236:239], a[104:107], v[124:127]
    v_mul_f32 v240, v224, v240
    v_exp_f32 v177, v177
    v_mfma_f32_16x16x32_bf16 v[116:119], a[232:235], a[108:111], v[116:119]
    v_mul_f32_e64 v241, v225, v241
    v_exp_f32 v178, v178
    v_mfma_f32_16x16x32_bf16 v[132:135], a[236:239], a[108:111], v[132:135]
    s_waitcnt lgkmcnt(4)
    ds_read_b64_tr_b16 a[232:233], v47 offset:4096
    v_mfma_f32_16x16x32_bf16 v[80:83], a[240:243], a[96:99], v[80:83]
    ds_read_b64_tr_b16 a[234:235], v47 offset:4608
    v_mul_f32_e64 v242, v226, v242
    v_mfma_f32_16x16x32_bf16 v[96:99], a[244:247], a[96:99], v[96:99]
    v_exp_f32 v179, v179
    v_mul_f32 v243, v227, v243
    v_mfma_f32_16x16x32_bf16 v[88:91], a[240:243], a[100:103], v[88:91]
    v_add_f32 v176, 1.0, v176
    v_add_f32 v177, 1.0, v177
    v_add_f32_e64 v178, 1.0, v178
    v_mfma_f32_16x16x32_bf16 v[104:107], a[244:247], a[100:103], v[104:107]
    v_add_f32 v179, 1.0, v179
    v_rcp_f32 v176, v176
    v_mfma_f32_16x16x32_bf16 v[112:115], a[240:243], a[104:107], v[112:115]
    ds_read_b64_tr_b16 a[236:237], v47 offset:12288
    ds_read_b64_tr_b16 a[238:239], v47 offset:12800
    v_mfma_f32_16x16x32_bf16 v[128:131], a[244:247], a[104:107], v[128:131]
    v_rcp_f32 v177, v177
    v_rcp_f32 v178, v178
    v_mfma_f32_16x16x32_bf16 v[120:123], a[240:243], a[108:111], v[120:123]
    v_rcp_f32 v179, v179
    v_mul_f32 v240, v240, v176
    v_mfma_f32_16x16x32_bf16 v[136:139], a[244:247], a[108:111], v[136:139]
    v_mul_f32 v241, v241, v177
    v_mul_f32 v242, v242, v178
    v_mul_f32 v243, v243, v179
    s_waitcnt lgkmcnt(4)
    v_mfma_f32_16x16x32_bf16 v[76:79], a[224:227], a[112:115], v[76:79]
    v_mfma_f32_16x16x32_bf16 v[92:95], a[228:231], a[112:115], v[92:95]
    s_waitcnt vmcnt(14) lgkmcnt(0)
    s_barrier
    ds_read_b64_tr_b16 a[240:241], v46 offset:49152
    v_mfma_f32_16x16x32_bf16 v[84:87], a[224:227], a[116:119], v[84:87]
    ds_read_b64_tr_b16 a[242:243], v46 offset:49664
    v_cvt_pk_bf16_f32 v150, v240, v241
    v_cvt_pk_bf16_f32 v151, v242, v243
    v_mfma_f32_16x16x32_bf16 v[100:103], a[228:231], a[116:119], v[100:103]
    buffer_store_dwordx4 v[148:151], v2, s[52:55], s75 offen offset:2048 sc1
    v_mul_f32 v180, v228, v228
    v_mul_f32 v181, v229, v229
    v_mfma_f32_16x16x32_bf16 v[108:111], a[224:227], a[120:123], v[108:111]
    v_mul_f32 v182, v230, v230
    v_mul_f32 v183, v231, v231
    v_fma_f32 v180, v180, v66, v68
    v_mfma_f32_16x16x32_bf16 v[124:127], a[228:231], a[120:123], v[124:127]
    ds_read_b64_tr_b16 a[244:245], v46 offset:57344
    ds_read_b64_tr_b16 a[246:247], v46 offset:57856
    v_fma_f32 v181, v181, v66, v68
    v_fma_f32 v182, v182, v66, v68
    v_fma_f32 v183, v183, v66, v68
    v_mfma_f32_16x16x32_bf16 v[116:119], a[224:227], a[124:127], v[116:119]
    s_add_u32 m0, s70, 65536
    s_nop 0
    buffer_load_dwordx4 v12, s[48:51], s9 offen offset:0  lds
    v_mul_f32 v180, v228, v180
    v_mul_f32_e64 v181, v229, v181
    v_mfma_f32_16x16x32_bf16 v[132:135], a[228:231], a[124:127], v[132:135]
    v_mul_f32 v182, v230, v182
    v_mul_f32 v183, v231, v183
    v_exp_f32_e64 v180, v180
    v_mfma_f32_16x16x32_bf16 v[80:83], a[232:235], a[112:115], v[80:83]
    ds_read_b64_tr_b16 a[224:225], v47 offset:49152
    ds_read_b64_tr_b16 a[226:227], v47 offset:49664
    v_mfma_f32_16x16x32_bf16 v[96:99], a[236:239], a[112:115], v[96:99]
    v_cmp_ne_u32 vcc, -1, v3
    s_nop 0
    s_cbranch_vccnz L_slow_1
L_ok_2:
    v_mul_f32 v244, v228, v244
    v_exp_f32 v181, v181
    v_mfma_f32_16x16x32_bf16 v[88:91], a[232:235], a[116:119], v[88:91]
    s_lshl_b32 s69, s67, 12
    s_add_u32 s69, s69, 13860992
    v_lshrrev_b32_e64 v60, 2, v1
    v_lshl_add_u32 v60, v60, 8, s69
    v_mfma_f32_16x16x32_bf16 v[104:107], a[236:239], a[116:119], v[104:107]
    buffer_load_dwordx4 v13, s[48:51], s9 offen offset:1024  lds
    v_mul_f32_e64 v245, v229, v245
    v_mfma_f32_16x16x32_bf16 v[112:115], a[232:235], a[120:123], v[112:115]
    ds_read_b64_tr_b16 a[228:229], v47 offset:57344
    ds_read_b64_tr_b16 a[230:231], v47 offset:57856
    v_exp_f32_e64 v182, v182
    v_mfma_f32_16x16x32_bf16 v[128:131], a[236:239], a[120:123], v[128:131]
    v_mul_f32 v246, v230, v246
    v_exp_f32 v183, v183
    v_mfma_f32_16x16x32_bf16 v[120:123], a[232:235], a[124:127], v[120:123]
    buffer_load_dwordx4 v14, s[48:51], s9 offen offset:2048  lds
    v_mul_f32 v247, v231, v247
    v_add_f32 v180, 1.0, v180
    v_add_f32 v181, 1.0, v181
    v_add_f32 v182, 1.0, v182
    v_add_f32 v183, 1.0, v183
    v_mfma_f32_16x16x32_bf16 v[136:139], a[236:239], a[124:127], v[136:139]
    s_waitcnt lgkmcnt(4)
    ds_read_b64_tr_b16 a[232:233], v46 offset:53248
    v_mfma_f32_16x16x32_bf16 v[76:79], a[240:243], a[128:131], v[76:79]
    ds_read_b64_tr_b16 a[234:235], v46 offset:53760
    v_rcp_f32 v180, v180
    v_rcp_f32 v181, v181
    v_mfma_f32_16x16x32_bf16 v[92:95], a[244:247], a[128:131], v[92:95]
    buffer_load_dword v3, v60, s[52:55], 0 offen sc1
    v_rcp_f32_e64 v182, v182
    v_mfma_f32_16x16x32_bf16 v[84:87], a[240:243], a[132:135], v[84:87]
    v_rcp_f32 v183, v183
    v_mul_f32 v244, v244, v180
    v_mul_f32_e64 v245, v245, v181
    v_mfma_f32_16x16x32_bf16 v[100:103], a[244:247], a[132:135], v[100:103]
    ds_read_b64_tr_b16 a[236:237], v46 offset:61440
    ds_read_b64_tr_b16 a[238:239], v46 offset:61952
    v_mul_f32_e64 v246, v246, v182
    v_mfma_f32_16x16x32_bf16 v[108:111], a[240:243], a[136:139], v[108:111]
    v_mul_f32_e64 v247, v247, v183
    v_cvt_pk_bf16_f32 v152, v244, v245
    v_cvt_pk_bf16_f32 v153, v246, v247
    v_mul_f32_e64 v184, v232, v232
    v_mfma_f32_16x16x32_bf16 v[124:127], a[244:247], a[136:139], v[124:127]
    buffer_load_dwordx4 v15, s[48:51], s9 offen offset:3072  lds
    v_mul_f32 v185, v233, v233
    v_mul_f32 v186, v234, v234
    v_mfma_f32_16x16x32_bf16 v[116:119], a[240:243], a[140:143], v[116:119]
    v_mul_f32 v187, v235, v235
    v_fma_f32 v184, v184, v66, v68
    v_fma_f32 v185, v185, v66, v68
    v_mfma_f32_16x16x32_bf16 v[132:135], a[244:247], a[140:143], v[132:135]
    s_waitcnt lgkmcnt(4)
    ds_read_b64_tr_b16 a[240:241], v47 offset:53248
    v_mfma_f32_16x16x32_bf16 v[80:83], a[224:227], a[128:131], v[80:83]
    ds_read_b64_tr_b16 a[242:243], v47 offset:53760
    v_fma_f32 v186, v186, v66, v68
    v_fma_f32 v187, v187, v66, v68
    v_mul_f32_e64 v184, v232, v184
    v_mfma_f32_16x16x32_bf16 v[96:99], a[228:231], a[128:131], v[96:99]
    s_add_u32 m0, s70, 32768
    s_nop 0
    buffer_load_dwordx4 v12, s[48:51], s10 offen offset:0  lds
    v_mul_f32 v185, v233, v185
    v_mul_f32_e64 v186, v234, v186
    v_mfma_f32_16x16x32_bf16 v[88:91], a[224:227], a[132:135], v[88:91]
    v_mul_f32 v187, v235, v187
    v_exp_f32 v184, v184
    v_mul_f32_e64 v248, v232, v248
    v_mfma_f32_16x16x32_bf16 v[104:107], a[228:231], a[132:135], v[104:107]
    ds_read_b64_tr_b16 a[244:245], v47 offset:61440
    ds_read_b64_tr_b16 a[246:247], v47 offset:61952
    v_exp_f32_e64 v185, v185
    v_mfma_f32_16x16x32_bf16 v[112:115], a[224:227], a[136:139], v[112:115]
    v_mul_f32 v249, v233, v249
    v_exp_f32 v186, v186
    v_mfma_f32_16x16x32_bf16 v[128:131], a[228:231], a[136:139], v[128:131]
    buffer_load_dwordx4 v13, s[48:51], s10 offen offset:1024  lds
    v_mul_f32_e64 v250, v234, v250
    v_mfma_f32_16x16x32_bf16 v[120:123], a[224:227], a[140:143], v[120:123]
    v_exp_f32 v187, v187
    v_mul_f32 v251, v235, v251
    v_add_f32_e64 v184, 1.0, v184
    v_mfma_f32_16x16x32_bf16 v[136:139], a[228:231], a[140:143], v[136:139]
    s_waitcnt lgkmcnt(4)
    ds_read_b64_tr_b16 a[224:225], v50 offset:0
    v_mfma_f32_16x16x32_bf16 v[76:79], a[232:235], a[144:147], v[76:79]
    ds_read_b64_tr_b16 a[226:227], v50 offset:512
    s_waitcnt vmcnt(17)
    v_mfma_f32_16x16x32_bf16 v[92:95], a[236:239], a[144:147], v[92:95]
    ds_read_b64_tr_b16 a[0:1], v53 offset:32768
    ds_read_b64_tr_b16 a[2:3], v53 offset:34816
    v_add_f32_e64 v185, 1.0, v185
    v_mfma_f32_16x16x32_bf16 v[84:87], a[232:235], a[148:151], v[84:87]
    buffer_load_dwordx4 v14, s[48:51], s10 offen offset:2048  lds
    v_add_f32 v186, 1.0, v186
    v_add_f32 v187, 1.0, v187
    v_mfma_f32_16x16x32_bf16 v[100:103], a[236:239], a[148:151], v[100:103]
    v_rcp_f32 v184, v184
    v_rcp_f32 v185, v185
    v_mfma_f32_16x16x32_bf16 v[108:111], a[232:235], a[152:155], v[108:111]
    ds_read_b64_tr_b16 a[228:229], v50 offset:8192
    ds_read_b64_tr_b16 a[230:231], v50 offset:8704
    ds_read_b64_tr_b16 a[4:5], v55 offset:32768
    v_mfma_f32_16x16x32_bf16 v[124:127], a[236:239], a[152:155], v[124:127]
    ds_read_b64_tr_b16 a[6:7], v55 offset:34816
    v_rcp_f32_e64 v186, v186
    v_mfma_f32_16x16x32_bf16 v[116:119], a[232:235], a[156:159], v[116:119]
    buffer_load_dwordx4 v15, s[48:51], s10 offen offset:3072  lds
    v_rcp_f32_e64 v187, v187
    v_mfma_f32_16x16x32_bf16 v[132:135], a[236:239], a[156:159], v[132:135]
    v_mul_f32 v248, v248, v184
    v_mul_f32 v249, v249, v185
    v_mul_f32 v250, v250, v186
    s_waitcnt lgkmcnt(8)
    v_mfma_f32_16x16x32_bf16 v[80:83], a[240:243], a[144:147], v[80:83]
    ds_read_b64_tr_b16 a[232:233], v51 offset:0
    ds_read_b64_tr_b16 a[234:235], v51 offset:512
    v_mfma_f32_16x16x32_bf16 v[96:99], a[244:247], a[144:147], v[96:99]
    ds_read_b64_tr_b16 a[8:9], v53 offset:32776
    v_mfma_f32_16x16x32_bf16 v[88:91], a[240:243], a[148:151], v[88:91]
    ds_read_b64_tr_b16 a[10:11], v53 offset:34824
    v_mul_f32_e64 v251, v251, v187
    v_mfma_f32_16x16x32_bf16 v[104:107], a[244:247], a[148:151], v[104:107]
    v_cvt_pk_bf16_f32 v154, v248, v249
    v_cvt_pk_bf16_f32 v155, v250, v251
    v_mfma_f32_16x16x32_bf16 v[112:115], a[240:243], a[152:155], v[112:115]
    buffer_store_dwordx4 v[152:155], v2, s[52:55], s75 offen offset:3072 sc1
    v_mfma_f32_16x16x32_bf16 v[128:131], a[244:247], a[152:155], v[128:131]
    ds_read_b64_tr_b16 a[236:237], v51 offset:8192
    ds_read_b64_tr_b16 a[238:239], v51 offset:8704
    v_mfma_f32_16x16x32_bf16 v[120:123], a[240:243], a[156:159], v[120:123]
    ds_read_b64_tr_b16 a[12:13], v55 offset:32776
    ds_read_b64_tr_b16 a[14:15], v55 offset:34824
    v_mfma_f32_16x16x32_bf16 v[136:139], a[244:247], a[156:159], v[136:139]
    s_waitcnt lgkmcnt(10)
    ds_read_b64_tr_b16 a[240:241], v50 offset:4096
    v_mfma_f32_16x16x32_bf16 v[76:79], a[224:227], a[160:163], v[76:79]
    ds_read_b64_tr_b16 a[242:243], v50 offset:4608
    s_waitcnt vmcnt(6)
    v_mfma_f32_16x16x32_bf16 v[92:95], a[228:231], a[160:163], v[92:95]
    v_cmp_ne_u32_e64 vcc, -1, v3
    s_nop 0
    s_cbranch_vccnz L_slow_4
L_ok_5:
    v_mfma_f32_16x16x32_bf16 v[84:87], a[224:227], a[164:167], v[84:87]
    s_mul_i32 s71, s66, 5056
    s_lshl_b32 s69, s67, 11
    s_add_u32 s71, s71, s69
    s_add_u32 m0, s71, 9280
    v_mfma_f32_16x16x32_bf16 v[100:103], a[228:231], a[164:167], v[100:103]
    s_lshl2_add_u32 s71, s61, s60
    s_lshl_b32 s71, s71, 11
    s_add_u32 s71, s71, 8388608
    v_mfma_f32_16x16x32_bf16 v[108:111], a[224:227], a[168:171], v[108:111]
    buffer_load_dwordx4 v2, s[52:55], s71 offen offset:0 sc1 lds
    ds_read_b64_tr_b16 a[244:245], v50 offset:12288
    v_mfma_f32_16x16x32_bf16 v[124:127], a[228:231], a[168:171], v[124:127]
    ds_read_b64_tr_b16 a[246:247], v50 offset:12800
    ds_read_b64_tr_b16 a[16:17], v52 offset:16384
    v_mfma_f32_16x16x32_bf16 v[116:119], a[224:227], a[172:175], v[116:119]
    ds_read_b64_tr_b16 a[18:19], v52 offset:18432
    buffer_load_dwordx4 v2, s[52:55], s71 offen offset:1024 sc1 lds
    v_mfma_f32_16x16x32_bf16 v[132:135], a[228:231], a[172:175], v[132:135]
    s_waitcnt lgkmcnt(8)
    ds_read_b64_tr_b16 a[224:225], v51 offset:4096
    v_mfma_f32_16x16x32_bf16 v[80:83], a[232:235], a[160:163], v[80:83]
    ds_read_b64_tr_b16 a[226:227], v51 offset:4608
    ds_read_b64_tr_b16 a[20:21], v54 offset:16384
    v_mfma_f32_16x16x32_bf16 v[96:99], a[236:239], a[160:163], v[96:99]
    ds_read_b64_tr_b16 a[22:23], v54 offset:18432
    s_waitcnt lgkmcnt(10)
    v_mfma_f32_16x16x32_bf16 v[88:91], a[232:235], a[164:167], v[88:91]
L_pad3:
    s_cbranch_execz L_ret
    s_nop 0
    s_add_u32 m0, s70, 131072
    s_nop 0
    buffer_load_dwordx4 v12, s[48:51], s11 offen offset:0  lds
    v_mfma_f32_16x16x32_bf16 v[104:107], a[236:239], a[164:167], v[104:107]
    ds_read_b64_tr_b16 a[228:229], v51 offset:12288
    v_mfma_f32_16x16x32_bf16 v[112:115], a[232:235], a[168:171], v[112:115]
    ds_read_b64_tr_b16 a[230:231], v51 offset:12800
    v_mfma_f32_16x16x32_bf16 v[128:131], a[236:239], a[168:171], v[128:131]
    ds_read_b64_tr_b16 a[24:25], v52 offset:16392
    ds_read_b64_tr_b16 a[26:27], v52 offset:18440
    v_mfma_f32_16x16x32_bf16 v[120:123], a[232:235], a[172:175], v[120:123]
    buffer_load_dwordx4 v13, s[48:51], s11 offen offset:1024  lds
    v_mfma_f32_16x16x32_bf16 v[136:139], a[236:239], a[172:175], v[136:139]
    s_waitcnt lgkmcnt(10)
    ds_read_b64_tr_b16 a[232:233], v50 offset:16384
    v_mfma_f32_16x16x32_bf16 v[76:79], a[240:243], a[176:179], v[76:79]
    ds_read_b64_tr_b16 a[234:235], v50 offset:16896
    v_mfma_f32_16x16x32_bf16 v[92:95], a[244:247], a[176:179], v[92:95]
    ds_read_b64_tr_b16 a[28:29], v54 offset:16392
    v_mfma_f32_16x16x32_bf16 v[84:87], a[240:243], a[180:183], v[84:87]
    ds_read_b64_tr_b16 a[30:31], v54 offset:18440
    v_mfma_f32_16x16x32_bf16 v[100:103], a[244:247], a[180:183], v[100:103]
    buffer_load_dwordx4 v14, s[48:51], s11 offen offset:2048  lds
    v_mfma_f32_16x16x32_bf16 v[108:111], a[240:243], a[184:187], v[108:111]
    ds_read_b64_tr_b16 a[236:237], v50 offset:24576
    v_mfma_f32_16x16x32_bf16 v[124:127], a[244:247], a[184:187], v[124:127]
    ds_read_b64_tr_b16 a[238:239], v50 offset:25088
    v_mfma_f32_16x16x32_bf16 v[116:119], a[240:243], a[188:191], v[116:119]
    buffer_load_dwordx4 v15, s[48:51], s11 offen offset:3072  lds
    v_mfma_f32_16x16x32_bf16 v[132:135], a[244:247], a[188:191], v[132:135]
    s_waitcnt lgkmcnt(8)
    ds_read_b64_tr_b16 a[240:241], v51 offset:16384
    v_mfma_f32_16x16x32_bf16 v[80:83], a[224:227], a[176:179], v[80:83]
    ds_read_b64_tr_b16 a[242:243], v51 offset:16896
    ds_read_b64_tr_b16 a[32:33], v53 offset:49152
    v_mfma_f32_16x16x32_bf16 v[96:99], a[228:231], a[176:179], v[96:99]
    ds_read_b64_tr_b16 a[34:35], v53 offset:51200
    s_waitcnt lgkmcnt(6)
    v_mfma_f32_16x16x32_bf16 v[88:91], a[224:227], a[180:183], v[88:91]
    s_add_u32 m0, s70, 49152
    s_nop 0
    buffer_load_dwordx4 v12, s[48:51], s12 offen offset:0  lds
    v_mfma_f32_16x16x32_bf16 v[104:107], a[228:231], a[180:183], v[104:107]
    ds_read_b64_tr_b16 a[244:245], v51 offset:24576
    v_mfma_f32_16x16x32_bf16 v[112:115], a[224:227], a[184:187], v[112:115]
    ds_read_b64_tr_b16 a[246:247], v51 offset:25088
    v_mfma_f32_16x16x32_bf16 v[128:131], a[228:231], a[184:187], v[128:131]
    ds_read_b64_tr_b16 a[36:37], v55 offset:49152
    ds_read_b64_tr_b16 a[38:39], v55 offset:51200
    v_mfma_f32_16x16x32_bf16 v[120:123], a[224:227], a[188:191], v[120:123]
    buffer_load_dwordx4 v13, s[48:51], s12 offen offset:1024  lds
    v_mfma_f32_16x16x32_bf16 v[136:139], a[228:231], a[188:191], v[136:139]
    s_waitcnt lgkmcnt(8)
    ds_read_b64_tr_b16 a[224:225], v50 offset:20480
    v_mfma_f32_16x16x32_bf16 v[76:79], a[232:235], a[192:195], v[76:79]
    ds_read_b64_tr_b16 a[226:227], v50 offset:20992
    v_mfma_f32_16x16x32_bf16 v[92:95], a[236:239], a[192:195], v[92:95]
    ds_read_b64_tr_b16 a[40:41], v53 offset:49160
    v_mfma_f32_16x16x32_bf16 v[84:87], a[232:235], a[196:199], v[84:87]
    ds_read_b64_tr_b16 a[42:43], v53 offset:51208
    v_mfma_f32_16x16x32_bf16 v[100:103], a[236:239], a[196:199], v[100:103]
    buffer_load_dwordx4 v14, s[48:51], s12 offen offset:2048  lds
    v_mfma_f32_16x16x32_bf16 v[108:111], a[232:235], a[200:203], v[108:111]
    ds_read_b64_tr_b16 a[228:229], v50 offset:28672
    ds_read_b64_tr_b16 a[230:231], v50 offset:29184
    v_mfma_f32_16x16x32_bf16 v[124:127], a[236:239], a[200:203], v[124:127]
    ds_read_b64_tr_b16 a[44:45], v55 offset:49160
    v_mfma_f32_16x16x32_bf16 v[116:119], a[232:235], a[204:207], v[116:119]
    ds_read_b64_tr_b16 a[46:47], v55 offset:51208
    s_waitcnt vmcnt(9)
    v_mfma_f32_16x16x32_bf16 v[132:135], a[236:239], a[204:207], v[132:135]
    s_mov_b32 s69, 0
    s_mov_b32 exec_hi, 0
    buffer_store_dword v56, v61, s[52:55], s69 offen sc1
    s_mov_b32 exec_hi, -1
    s_waitcnt lgkmcnt(10)
    v_mfma_f32_16x16x32_bf16 v[80:83], a[240:243], a[192:195], v[80:83]
    ds_read_b64_tr_b16 a[232:233], v51 offset:20480
    v_mfma_f32_16x16x32_bf16 v[96:99], a[244:247], a[192:195], v[96:99]
    ds_read_b64_tr_b16 a[234:235], v51 offset:20992
    v_mfma_f32_16x16x32_bf16 v[88:91], a[240:243], a[196:199], v[88:91]
    buffer_load_dwordx4 v15, s[48:51], s12 offen offset:3072  lds
    v_mfma_f32_16x16x32_bf16 v[104:107], a[244:247], a[196:199], v[104:107]
    ds_read_b64_tr_b16 a[236:237], v51 offset:28672
    v_mfma_f32_16x16x32_bf16 v[112:115], a[240:243], a[200:203], v[112:115]
    ds_read_b64_tr_b16 a[238:239], v51 offset:29184
    ds_read_b64_tr_b16 a[48:49], v52 offset:32768
    v_mfma_f32_16x16x32_bf16 v[128:131], a[244:247], a[200:203], v[128:131]
    ds_read_b64_tr_b16 a[50:51], v52 offset:34816
    s_waitcnt lgkmcnt(6)
    v_mfma_f32_16x16x32_bf16 v[120:123], a[240:243], a[204:207], v[120:123]
    s_add_u32 m0, s70, 147456
    s_add_u32 s71, s6, 802816
    v_mfma_f32_16x16x32_bf16 v[136:139], a[244:247], a[204:207], v[136:139]
    buffer_load_dwordx4 v12, s[48:51], s71 offen offset:0  lds
    v_mfma_f32_16x16x32_bf16 v[76:79], a[224:227], a[208:211], v[76:79]
    v_mfma_f32_16x16x32_bf16 v[92:95], a[228:231], a[208:211], v[92:95]
    s_waitcnt vmcnt(10) lgkmcnt(0)
    s_barrier
    ds_read_b64_tr_b16 a[192:193], v57 offset:32
    ds_read_b64_tr_b16 a[194:195], v57 offset:0
    v_mfma_f32_16x16x32_bf16 v[84:87], a[224:227], a[212:215], v[84:87]
    ds_read_b64_tr_b16 a[196:197], v57 offset:1056
    ds_read_b64_tr_b16 a[198:199], v57 offset:1024
    v_mfma_f32_16x16x32_bf16 v[100:103], a[228:231], a[212:215], v[100:103]
    ds_read_b64_tr_b16 a[52:53], v54 offset:32768
    ds_read_b64_tr_b16 a[54:55], v54 offset:34816
    v_mfma_f32_16x16x32_bf16 v[108:111], a[224:227], a[216:219], v[108:111]
    buffer_load_dwordx4 v13, s[48:51], s71 offen offset:1024  lds
    ds_read_b64_tr_b16 a[200:201], v57 offset:2080
    v_mfma_f32_16x16x32_bf16 v[124:127], a[228:231], a[216:219], v[124:127]
    ds_read_b64_tr_b16 a[202:203], v57 offset:2048
    ds_read_b64_tr_b16 a[204:205], v57 offset:3104
    v_mfma_f32_16x16x32_bf16 v[116:119], a[224:227], a[220:223], v[116:119]
    ds_read_b64_tr_b16 a[206:207], v57 offset:3072
    ds_read_b64_tr_b16 a[56:57], v52 offset:32776
    v_mfma_f32_16x16x32_bf16 v[132:135], a[228:231], a[220:223], v[132:135]
    ds_read_b64_tr_b16 a[58:59], v52 offset:34824
    buffer_load_dwordx4 v14, s[48:51], s71 offen offset:2048  lds
    v_mfma_f32_16x16x32_bf16 v[80:83], a[232:235], a[208:211], v[80:83]
    ds_read_b128 v[164:167], v58 offset:3840
    ds_read_b128 v[168:171], v58 offset:4352
    v_mfma_f32_16x16x32_bf16 v[96:99], a[236:239], a[208:211], v[96:99]
    ds_read_b128 v[156:159], v58 offset:2816
    ds_read_b128 v[160:163], v58 offset:3328
    v_mfma_f32_16x16x32_bf16 v[88:91], a[232:235], a[212:215], v[88:91]
    ds_read_b64_tr_b16 a[60:61], v54 offset:32776
    ds_read_b64_tr_b16 a[62:63], v54 offset:34824
    v_mfma_f32_16x16x32_bf16 v[104:107], a[236:239], a[212:215], v[104:107]
    buffer_load_dwordx4 v15, s[48:51], s71 offen offset:3072  lds
    v_mfma_f32_16x16x32_bf16 v[112:115], a[232:235], a[216:219], v[112:115]
    ds_read_b128 v[148:151], v58 offset:1792
    v_mfma_f32_16x16x32_bf16 v[128:131], a[236:239], a[216:219], v[128:131]
    ds_read_b128 v[152:155], v58 offset:2304
    v_mfma_f32_16x16x32_bf16 v[120:123], a[232:235], a[220:223], v[120:123]
    ds_read_b128 v[140:143], v58 offset:768
    v_mfma_f32_16x16x32_bf16 v[136:139], a[236:239], a[220:223], v[136:139]
    ds_read_b128 v[144:147], v58 offset:1280
    s_add_u32 m0, s70, 81920
    s_add_u32 s71, s7, 802816
    v_pk_mul_f32 v[172:173], v[76:77], v[76:77]
    v_pk_mul_f32 v[174:175], v[78:79], v[78:79]
    v_pk_mul_f32 v[176:177], v[80:81], v[80:81]
    v_pk_mul_f32 v[178:179], v[82:83], v[82:83]
    v_pk_mul_f32 v[180:181], v[84:85], v[84:85]
    v_pk_mul_f32 v[182:183], v[86:87], v[86:87]
    v_pk_mul_f32 v[184:185], v[88:89], v[88:89]
    v_pk_mul_f32 v[186:187], v[90:91], v[90:91]
    v_pk_fma_f32 v[172:173], v[172:173], v[66:67], v[68:69]
    v_pk_fma_f32 v[174:175], v[174:175], v[66:67], v[68:69]
    v_pk_fma_f32 v[176:177], v[176:177], v[66:67], v[68:69]
    v_pk_fma_f32 v[178:179], v[178:179], v[66:67], v[68:69]
    v_pk_fma_f32 v[180:181], v[180:181], v[66:67], v[68:69]
    v_pk_fma_f32 v[182:183], v[182:183], v[66:67], v[68:69]
    v_pk_fma_f32 v[184:185], v[184:185], v[66:67], v[68:69]
    v_pk_fma_f32 v[186:187], v[186:187], v[66:67], v[68:69]
    v_pk_mul_f32 v[172:173], v[76:77], v[172:173]
    v_pk_mul_f32 v[174:175], v[78:79], v[174:175]
    v_pk_mul_f32 v[176:177], v[80:81], v[176:177]
    v_pk_mul_f32 v[178:179], v[82:83], v[178:179]
    v_pk_mul_f32 v[180:181], v[84:85], v[180:181]
    v_pk_mul_f32 v[182:183], v[86:87], v[182:183]
    v_pk_mul_f32 v[184:185], v[88:89], v[184:185]
    v_pk_mul_f32 v[186:187], v[90:91], v[186:187]
    v_pk_mul_f32 v[92:93], v[76:77], v[92:93]
    v_pk_mul_f32 v[94:95], v[78:79], v[94:95]
    v_pk_mul_f32 v[96:97], v[80:81], v[96:97]
    v_pk_mul_f32 v[98:99], v[82:83], v[98:99]
    v_pk_mul_f32 v[100:101], v[84:85], v[100:101]
    v_pk_mul_f32 v[102:103], v[86:87], v[102:103]
    v_pk_mul_f32 v[104:105], v[88:89], v[104:105]
    v_pk_mul_f32 v[106:107], v[90:91], v[106:107]
    buffer_load_dwordx4 v12, s[48:51], s71 offen offset:0  lds
    s_waitcnt lgkmcnt(6)
    buffer_load_dwordx4 v13, s[48:51], s71 offen offset:1024  lds
    ds_read_b64_tr_b16 a[64:65], v52 offset:0
    ds_read_b64_tr_b16 a[66:67], v52 offset:2048
    v_exp_f32 v172, v172
    v_mfma_f32_16x16x32_bf16 v[236:239], a[192:195], v[164:167], 0
    v_exp_f32_e64 v173, v173
    v_mfma_f32_16x16x32_bf16 v[244:247], a[192:195], v[168:171], 0
    v_exp_f32 v174, v174
    v_exp_f32 v175, v175
    v_mfma_f32_16x16x32_bf16 v[220:223], a[192:195], v[156:159], 0
    buffer_load_dwordx4 v14, s[48:51], s71 offen offset:2048  lds
    ds_read_b64_tr_b16 a[240:241], v57 offset:40
    v_exp_f32 v176, v176
    v_exp_f32 v177, v177
    v_exp_f32 v178, v178
    v_exp_f32 v179, v179
    v_exp_f32_e64 v180, v180
    v_mfma_f32_16x16x32_bf16 v[228:231], a[192:195], v[160:163], 0
    buffer_load_dwordx4 v15, s[48:51], s71 offen offset:3072  lds
    ds_read_b64_tr_b16 a[242:243], v57 offset:8
    v_mfma_f32_16x16x32_bf16 v[236:239], a[196:199], v[156:159], v[236:239]
    ds_read_b64_tr_b16 a[244:245], v57 offset:1064
    ds_read_b64_tr_b16 a[246:247], v57 offset:1032
    ds_read_b64_tr_b16 a[68:69], v54 offset:0
    v_mfma_f32_16x16x32_bf16 v[244:247], a[196:199], v[160:163], v[244:247]
    ds_read_b64_tr_b16 a[70:71], v54 offset:2048
    v_exp_f32_e64 v181, v181
    v_exp_f32 v182, v182
    s_waitcnt lgkmcnt(10)
    v_mfma_f32_16x16x32_bf16 v[204:207], a[192:195], v[148:151], 0
    s_add_u32 m0, s70, 98304
    s_add_u32 s71, s8, 802816
    buffer_load_dwordx4 v12, s[48:51], s71 offen offset:0  lds
    v_mfma_f32_16x16x32_bf16 v[212:215], a[192:195], v[152:155], 0
    ds_read_b64_tr_b16 a[248:249], v57 offset:2088
    v_exp_f32 v183, v183
    v_exp_f32 v184, v184
    v_exp_f32 v185, v185
    v_exp_f32 v186, v186
    v_exp_f32_e64 v187, v187
    v_pk_add_f32 v[172:173], v[172:173], 1.0 op_sel_hi:[1,0]
    v_pk_add_f32 v[174:175], v[174:175], 1.0 op_sel_hi:[1,0]
    v_pk_add_f32 v[176:177], v[176:177], 1.0 op_sel_hi:[1,0]
    v_pk_add_f32 v[178:179], v[178:179], 1.0 op_sel_hi:[1,0]
    v_pk_add_f32 v[180:181], v[180:181], 1.0 op_sel_hi:[1,0]
    v_pk_add_f32 v[182:183], v[182:183], 1.0 op_sel_hi:[1,0]
    v_pk_add_f32 v[184:185], v[184:185], 1.0 op_sel_hi:[1,0]
    v_pk_add_f32 v[186:187], v[186:187], 1.0 op_sel_hi:[1,0]
    v_mfma_f32_16x16x32_bf16 v[220:223], a[196:199], v[148:151], v[220:223]
    buffer_load_dwordx4 v13, s[48:51], s71 offen offset:1024  lds
    ds_read_b64_tr_b16 a[250:251], v57 offset:2056
    ds_read_b64_tr_b16 a[252:253], v57 offset:3112
    v_mfma_f32_16x16x32_bf16 v[228:231], a[196:199], v[152:155], v[228:231]
    ds_read_b64_tr_b16 a[254:255], v57 offset:3080
    ds_read_b64_tr_b16 a[72:73], v52 offset:8
    v_mfma_f32_16x16x32_bf16 v[236:239], a[200:203], v[148:151], v[236:239]
    ds_read_b64_tr_b16 a[74:75], v52 offset:2056
    v_rcp_f32 v172, v172
    v_rcp_f32 v173, v173
    v_rcp_f32_e64 v174, v174
    v_mfma_f32_16x16x32_bf16 v[244:247], a[200:203], v[152:155], v[244:247]
    buffer_load_dwordx4 v14, s[48:51], s71 offen offset:2048  lds
    v_rcp_f32 v175, v175
    v_rcp_f32 v176, v176
    v_rcp_f32 v177, v177
    v_rcp_f32 v178, v178
    v_rcp_f32 v179, v179
    s_waitcnt lgkmcnt(14)
    v_mfma_f32_16x16x32_bf16 v[188:191], a[192:195], v[140:143], 0
    buffer_load_dwordx4 v15, s[48:51], s71 offen offset:3072  lds
    ds_read_b64_tr_b16 a[76:77], v54 offset:8
    v_mfma_f32_16x16x32_bf16 v[196:199], a[192:195], v[144:147], 0
    ds_read_b64_tr_b16 a[78:79], v54 offset:2056
    v_rcp_f32 v180, v180
    v_rcp_f32 v181, v181
    v_mfma_f32_16x16x32_bf16 v[204:207], a[196:199], v[140:143], v[204:207]
    v_rcp_f32 v182, v182
    v_rcp_f32 v183, v183
    v_mfma_f32_16x16x32_bf16 v[212:215], a[196:199], v[144:147], v[212:215]
    v_rcp_f32 v184, v184
    v_rcp_f32 v185, v185
    v_rcp_f32 v186, v186
    v_rcp_f32 v187, v187
    v_pk_mul_f32 v[92:93], v[92:93], v[172:173]
    v_pk_mul_f32 v[94:95], v[94:95], v[174:175]
    v_pk_mul_f32 v[96:97], v[96:97], v[176:177]
    v_pk_mul_f32 v[98:99], v[98:99], v[178:179]
    v_pk_mul_f32 v[100:101], v[100:101], v[180:181]
    v_pk_mul_f32 v[102:103], v[102:103], v[182:183]
    v_pk_mul_f32 v[104:105], v[104:105], v[184:185]
    v_pk_mul_f32 v[106:107], v[106:107], v[186:187]
    v_cvt_pk_bf16_f32 v28, v92, v93
    v_cvt_pk_bf16_f32 v29, v94, v95
    v_cvt_pk_bf16_f32 v30, v96, v97
    v_cvt_pk_bf16_f32 v31, v98, v99
    buffer_store_dwordx4 v[28:31], v2, s[52:55], s76 offen offset:0 sc1
    v_cvt_pk_bf16_f32 v32, v100, v101
    v_cvt_pk_bf16_f32 v33, v102, v103
    v_cvt_pk_bf16_f32 v34, v104, v105
    v_cvt_pk_bf16_f32 v35, v106, v107
    buffer_store_dwordx4 v[32:35], v2, s[52:55], s76 offen offset:1024 sc1
    v_pk_mul_f32 v[172:173], v[108:109], v[108:109]
    v_pk_mul_f32 v[174:175], v[110:111], v[110:111]
    v_pk_mul_f32 v[176:177], v[112:113], v[112:113]
    v_pk_mul_f32 v[178:179], v[114:115], v[114:115]
    v_pk_mul_f32 v[180:181], v[116:117], v[116:117]
    v_pk_mul_f32 v[182:183], v[118:119], v[118:119]
    v_pk_mul_f32 v[184:185], v[120:121], v[120:121]
    v_pk_mul_f32 v[186:187], v[122:123], v[122:123]
    v_pk_fma_f32 v[172:173], v[172:173], v[66:67], v[68:69]
    v_pk_fma_f32 v[174:175], v[174:175], v[66:67], v[68:69]
    v_pk_fma_f32 v[176:177], v[176:177], v[66:67], v[68:69]
    v_pk_fma_f32 v[178:179], v[178:179], v[66:67], v[68:69]
    v_pk_fma_f32 v[180:181], v[180:181], v[66:67], v[68:69]
    v_pk_fma_f32 v[182:183], v[182:183], v[66:67], v[68:69]
    v_pk_fma_f32 v[184:185], v[184:185], v[66:67], v[68:69]
    v_pk_fma_f32 v[186:187], v[186:187], v[66:67], v[68:69]
    v_pk_mul_f32 v[172:173], v[108:109], v[172:173]
    v_pk_mul_f32 v[174:175], v[110:111], v[174:175]
    v_pk_mul_f32 v[176:177], v[112:113], v[176:177]
    v_pk_mul_f32 v[178:179], v[114:115], v[178:179]
    v_pk_mul_f32 v[180:181], v[116:117], v[180:181]
    v_pk_mul_f32 v[182:183], v[118:119], v[182:183]
    v_pk_mul_f32 v[184:185], v[120:121], v[184:185]
    v_pk_mul_f32 v[186:187], v[122:123], v[186:187]
    v_pk_mul_f32 v[124:125], v[108:109], v[124:125]
    v_pk_mul_f32 v[126:127], v[110:111], v[126:127]
    v_pk_mul_f32 v[128:129], v[112:113], v[128:129]
    v_pk_mul_f32 v[130:131], v[114:115], v[130:131]
    v_pk_mul_f32 v[132:133], v[116:117], v[132:133]
    v_pk_mul_f32 v[134:135], v[118:119], v[134:135]
    v_pk_mul_f32 v[136:137], v[120:121], v[136:137]
    v_pk_mul_f32 v[138:139], v[122:123], v[138:139]
    s_add_u32 m0, s70, 114688
    s_add_u32 s71, s9, 802816
    buffer_load_dwordx4 v12, s[48:51], s71 offen offset:0  lds
    v_exp_f32_e64 v172, v172
    v_mfma_f32_16x16x32_bf16 v[220:223], a[200:203], v[140:143], v[220:223]
    v_exp_f32 v173, v173
    v_exp_f32 v174, v174
    v_exp_f32 v175, v175
    v_exp_f32 v176, v176
    v_mfma_f32_16x16x32_bf16 v[228:231], a[200:203], v[144:147], v[228:231]
    buffer_load_dwordx4 v13, s[48:51], s71 offen offset:1024  lds
    v_exp_f32 v177, v177
    v_exp_f32 v178, v178
    v_mfma_f32_16x16x32_bf16 v[236:239], a[204:207], v[140:143], v[236:239]
    v_exp_f32 v179, v179
    v_exp_f32 v180, v180
    v_exp_f32 v181, v181
    v_mfma_f32_16x16x32_bf16 v[244:247], a[204:207], v[144:147], v[244:247]
    s_waitcnt lgkmcnt(4)
    buffer_load_dwordx4 v14, s[48:51], s71 offen offset:2048  lds
    ds_read_b64_tr_b16 a[224:225], v57 offset:288
    v_mfma_f32_16x16x32_bf16 v[240:243], a[240:243], v[164:167], 0
    ds_read_b64_tr_b16 a[226:227], v57 offset:256
    ds_read_b64_tr_b16 a[228:229], v57 offset:1312
    s_waitcnt vmcnt(22)
    ds_read_b64_tr_b16 a[80:81], v53 offset:32768
    v_mfma_f32_16x16x32_bf16 v[248:251], a[240:243], v[168:171], 0
    ds_read_b64_tr_b16 a[82:83], v53 offset:34816
    v_exp_f32 v182, v182
    v_exp_f32 v183, v183
    v_exp_f32 v184, v184
    v_mfma_f32_16x16x32_bf16 v[224:227], a[240:243], v[156:159], 0
    buffer_load_dwordx4 v15, s[48:51], s71 offen offset:3072  lds
    ds_read_b64_tr_b16 a[230:231], v57 offset:1280
    v_exp_f32 v185, v185
    v_exp_f32 v186, v186
    v_exp_f32_e64 v187, v187
    v_mfma_f32_16x16x32_bf16 v[232:235], a[240:243], v[160:163], 0
    v_pk_add_f32 v[172:173], v[172:173], 1.0 op_sel_hi:[1,0]
    v_pk_add_f32 v[174:175], v[174:175], 1.0 op_sel_hi:[1,0]
    v_pk_add_f32 v[176:177], v[176:177], 1.0 op_sel_hi:[1,0]
    v_pk_add_f32 v[178:179], v[178:179], 1.0 op_sel_hi:[1,0]
    v_pk_add_f32 v[180:181], v[180:181], 1.0 op_sel_hi:[1,0]
    v_pk_add_f32 v[182:183], v[182:183], 1.0 op_sel_hi:[1,0]
    v_pk_add_f32 v[184:185], v[184:185], 1.0 op_sel_hi:[1,0]
    v_pk_add_f32 v[186:187], v[186:187], 1.0 op_sel_hi:[1,0]
    v_mfma_f32_16x16x32_bf16 v[240:243], a[244:247], v[156:159], v[240:243]
    s_add_u32 m0, s70, 65536
    s_add_u32 s71, s10, 802816
    buffer_load_dwordx4 v12, s[48:51], s71 offen offset:0  lds
    v_mfma_f32_16x16x32_bf16 v[248:251], a[244:247], v[160:163], v[248:251]
    ds_read_b64_tr_b16 a[232:233], v57 offset:2336
    ds_read_b128 v[164:167], v58 offset:3584
    ds_read_b128 v[168:171], v58 offset:4096
    ds_read_b64_tr_b16 a[84:85], v55 offset:32768
    v_mfma_f32_16x16x32_bf16 v[208:211], a[240:243], v[148:151], 0
    ds_read_b64_tr_b16 a[86:87], v55 offset:34816
    v_rcp_f32 v172, v172
    v_rcp_f32 v173, v173
    v_rcp_f32_e64 v174, v174
    v_mfma_f32_16x16x32_bf16 v[216:219], a[240:243], v[152:155], 0
    buffer_load_dwordx4 v13, s[48:51], s71 offen offset:1024  lds
    ds_read_b64_tr_b16 a[234:235], v57 offset:2304
    v_rcp_f32 v175, v175
    v_rcp_f32 v176, v176
    v_rcp_f32 v177, v177
    v_rcp_f32 v178, v178
    v_rcp_f32_e64 v179, v179
    v_mfma_f32_16x16x32_bf16 v[224:227], a[244:247], v[148:151], v[224:227]
    buffer_load_dwordx4 v14, s[48:51], s71 offen offset:2048  lds
    ds_read_b64_tr_b16 a[236:237], v57 offset:3360
    ds_read_b128 v[156:159], v58 offset:2560
    ds_read_b128 v[160:163], v58 offset:3072
    ds_read_b64_tr_b16 a[88:89], v53 offset:32776
    v_mfma_f32_16x16x32_bf16 v[232:235], a[244:247], v[152:155], v[232:235]
    ds_read_b64_tr_b16 a[90:91], v53 offset:34824
    v_rcp_f32 v180, v180
    v_rcp_f32 v181, v181
    v_rcp_f32_e64 v182, v182
    v_mfma_f32_16x16x32_bf16 v[240:243], a[248:251], v[148:151], v[240:243]
    ds_read_b64_tr_b16 a[238:239], v57 offset:3328
    v_rcp_f32 v183, v183
    v_rcp_f32 v184, v184
    v_rcp_f32 v185, v185
    v_rcp_f32 v186, v186
    v_rcp_f32_e64 v187, v187
    v_mfma_f32_16x16x32_bf16 v[248:251], a[248:251], v[152:155], v[248:251]
    buffer_load_dword v3, v62, s[52:55], 0 offen sc1
    v_pk_mul_f32 v[124:125], v[124:125], v[172:173]
    v_pk_mul_f32 v[126:127], v[126:127], v[174:175]
    v_pk_mul_f32 v[128:129], v[128:129], v[176:177]
    v_pk_mul_f32 v[130:131], v[130:131], v[178:179]
    v_pk_mul_f32 v[132:133], v[132:133], v[180:181]
    v_pk_mul_f32 v[134:135], v[134:135], v[182:183]
    v_pk_mul_f32 v[136:137], v[136:137], v[184:185]
    v_pk_mul_f32 v[138:139], v[138:139], v[186:187]
    v_cvt_pk_bf16_f32 v36, v124, v125
    v_cvt_pk_bf16_f32 v37, v126, v127
    v_cvt_pk_bf16_f32 v38, v128, v129
    v_cvt_pk_bf16_f32 v39, v130, v131
    buffer_store_dwordx4 v[36:39], v2, s[52:55], s76 offen offset:2048 sc1
    v_cvt_pk_bf16_f32 v40, v132, v133
    v_cvt_pk_bf16_f32 v41, v134, v135
    v_cvt_pk_bf16_f32 v42, v136, v137
    v_cvt_pk_bf16_f32 v43, v138, v139
    buffer_store_dwordx4 v[40:43], v2, s[52:55], s76 offen offset:3072 sc1
    v_mfma_f32_16x16x32_bf16 v[192:195], a[240:243], v[140:143], 0
    ds_read_b128 v[148:151], v58 offset:1536
    v_mfma_f32_16x16x32_bf16 v[200:203], a[240:243], v[144:147], 0
    ds_read_b128 v[152:155], v58 offset:2048
    v_mfma_f32_16x16x32_bf16 v[208:211], a[244:247], v[140:143], v[208:211]
    ds_read_b64_tr_b16 a[92:93], v55 offset:32776
    v_mfma_f32_16x16x32_bf16 v[216:219], a[244:247], v[144:147], v[216:219]
    ds_read_b64_tr_b16 a[94:95], v55 offset:34824
    v_mfma_f32_16x16x32_bf16 v[224:227], a[248:251], v[140:143], v[224:227]
    v_mfma_f32_16x16x32_bf16 v[232:235], a[248:251], v[144:147], v[232:235]
    s_waitcnt lgkmcnt(4)
    v_mfma_f32_16x16x32_bf16 v[240:243], a[252:255], v[140:143], v[240:243]
    ds_read_b128 v[140:143], v58 offset:512
    v_mfma_f32_16x16x32_bf16 v[248:251], a[252:255], v[144:147], v[248:251]
    ds_read_b128 v[144:147], v58 offset:1024
    v_mfma_f32_16x16x32_bf16 v[236:239], a[224:227], v[164:167], v[236:239]
    s_waitcnt vmcnt(24)
    ds_read_b64_tr_b16 a[96:97], v52 offset:16384
    v_mfma_f32_16x16x32_bf16 v[244:247], a[224:227], v[168:171], v[244:247]
    ds_read_b64_tr_b16 a[98:99], v52 offset:18432
    v_mfma_f32_16x16x32_bf16 v[220:223], a[224:227], v[156:159], v[220:223]
    ds_read_b64_tr_b16 a[240:241], v57 offset:296
    buffer_load_dwordx4 v15, s[48:51], s71 offen offset:3072  lds
    v_mfma_f32_16x16x32_bf16 v[228:231], a[224:227], v[160:163], v[228:231]
    ds_read_b64_tr_b16 a[242:243], v57 offset:264
    ds_read_b64_tr_b16 a[244:245], v57 offset:1320
    v_mfma_f32_16x16x32_bf16 v[236:239], a[228:231], v[156:159], v[236:239]
    ds_read_b64_tr_b16 a[246:247], v57 offset:1288
    ds_read_b64_tr_b16 a[100:101], v54 offset:16384
    v_mfma_f32_16x16x32_bf16 v[244:247], a[228:231], v[160:163], v[244:247]
    ds_read_b64_tr_b16 a[102:103], v54 offset:18432
    s_nop 0
    s_waitcnt lgkmcnt(12)
    v_mfma_f32_16x16x32_bf16 v[204:207], a[224:227], v[148:151], v[204:207]
    s_add_u32 m0, s70, 32768
    s_add_u32 s71, s11, 802816
    v_mfma_f32_16x16x32_bf16 v[212:215], a[224:227], v[152:155], v[212:215]
    ds_read_b64_tr_b16 a[248:249], v57 offset:2344
    buffer_load_dwordx4 v12, s[48:51], s71 offen offset:0  lds
    v_mfma_f32_16x16x32_bf16 v[220:223], a[228:231], v[148:151], v[220:223]
    ds_read_b64_tr_b16 a[250:251], v57 offset:2312
    ds_read_b64_tr_b16 a[252:253], v57 offset:3368
    v_mfma_f32_16x16x32_bf16 v[228:231], a[228:231], v[152:155], v[228:231]
    ds_read_b64_tr_b16 a[254:255], v57 offset:3336
    ds_read_b64_tr_b16 a[104:105], v52 offset:16392
    v_mfma_f32_16x16x32_bf16 v[236:239], a[232:235], v[148:151], v[236:239]
    ds_read_b64_tr_b16 a[106:107], v52 offset:18440
    v_mfma_f32_16x16x32_bf16 v[244:247], a[232:235], v[152:155], v[244:247]
    buffer_load_dwordx4 v13, s[48:51], s71 offen offset:1024  lds
    s_waitcnt lgkmcnt(14)
    v_mfma_f32_16x16x32_bf16 v[188:191], a[224:227], v[140:143], v[188:191]
    ds_read_b64_tr_b16 a[108:109], v54 offset:16392
    v_mfma_f32_16x16x32_bf16 v[196:199], a[224:227], v[144:147], v[196:199]
    ds_read_b64_tr_b16 a[110:111], v54 offset:18440
    v_mfma_f32_16x16x32_bf16 v[204:207], a[228:231], v[140:143], v[204:207]
    v_mfma_f32_16x16x32_bf16 v[212:215], a[228:231], v[144:147], v[212:215]
    buffer_load_dwordx4 v14, s[48:51], s71 offen offset:2048  lds
    v_mfma_f32_16x16x32_bf16 v[220:223], a[232:235], v[140:143], v[220:223]
    buffer_load_dwordx4 v15, s[48:51], s71 offen offset:3072  lds
    v_mfma_f32_16x16x32_bf16 v[228:231], a[232:235], v[144:147], v[228:231]
    s_waitcnt lgkmcnt(4)
    v_mfma_f32_16x16x32_bf16 v[236:239], a[236:239], v[140:143], v[236:239]
    ds_read_b64_tr_b16 a[224:225], v57 offset:544
    v_mfma_f32_16x16x32_bf16 v[244:247], a[236:239], v[144:147], v[244:247]
    ds_read_b64_tr_b16 a[226:227], v57 offset:512
    v_mfma_f32_16x16x32_bf16 v[240:243], a[240:243], v[164:167], v[240:243]
    ds_read_b64_tr_b16 a[228:229], v57 offset:1568
    v_mfma_f32_16x16x32_bf16 v[248:251], a[240:243], v[168:171], v[248:251]
    s_add_u32 m0, s70, 131072
    s_add_u32 s71, s12, 802816
    v_mfma_f32_16x16x32_bf16 v[224:227], a[240:243], v[156:159], v[224:227]
    ds_read_b64_tr_b16 a[230:231], v57 offset:1536
    v_mfma_f32_16x16x32_bf16 v[232:235], a[240:243], v[160:163], v[232:235]
    buffer_load_dwordx4 v12, s[48:51], s71 offen offset:0  lds
    v_mfma_f32_16x16x32_bf16 v[240:243], a[244:247], v[156:159], v[240:243]
    ds_read_b64_tr_b16 a[232:233], v57 offset:2592
    v_mfma_f32_16x16x32_bf16 v[248:251], a[244:247], v[160:163], v[248:251]
    ds_read_b128 v[164:167], v58 offset:3328
    v_mfma_f32_16x16x32_bf16 v[208:211], a[240:243], v[148:151], v[208:211]
    ds_read_b128 v[168:171], v58 offset:3840
    v_mfma_f32_16x16x32_bf16 v[216:219], a[240:243], v[152:155], v[216:219]
    ds_read_b64_tr_b16 a[234:235], v57 offset:2560
    v_mfma_f32_16x16x32_bf16 v[224:227], a[244:247], v[148:151], v[224:227]
    buffer_load_dwordx4 v13, s[48:51], s71 offen offset:1024  lds
    v_mfma_f32_16x16x32_bf16 v[232:235], a[244:247], v[152:155], v[232:235]
    ds_read_b64_tr_b16 a[236:237], v57 offset:3616
    v_mfma_f32_16x16x32_bf16 v[240:243], a[248:251], v[148:151], v[240:243]
    ds_read_b128 v[156:159], v58 offset:2304
    v_mfma_f32_16x16x32_bf16 v[248:251], a[248:251], v[152:155], v[248:251]
    ds_read_b128 v[160:163], v58 offset:2816
    v_mfma_f32_16x16x32_bf16 v[192:195], a[240:243], v[140:143], v[192:195]
    ds_read_b64_tr_b16 a[238:239], v57 offset:3584
    v_mfma_f32_16x16x32_bf16 v[200:203], a[240:243], v[144:147], v[200:203]
    buffer_load_dwordx4 v14, s[48:51], s71 offen offset:2048  lds
    v_mfma_f32_16x16x32_bf16 v[208:211], a[244:247], v[140:143], v[208:211]
    ds_read_b128 v[148:151], v58 offset:1280
    v_mfma_f32_16x16x32_bf16 v[216:219], a[244:247], v[144:147], v[216:219]
    ds_read_b128 v[152:155], v58 offset:1792
    v_mfma_f32_16x16x32_bf16 v[224:227], a[248:251], v[140:143], v[224:227]
    buffer_load_dwordx4 v15, s[48:51], s71 offen offset:3072  lds
    v_mfma_f32_16x16x32_bf16 v[232:235], a[248:251], v[144:147], v[232:235]
    v_mfma_f32_16x16x32_bf16 v[240:243], a[252:255], v[140:143], v[240:243]
    s_waitcnt vmcnt(9)
    v_mfma_f32_16x16x32_bf16 v[248:251], a[252:255], v[144:147], v[248:251]
    s_mov_b32 s69, 114688
    s_mov_b32 exec_hi, 0
    buffer_store_dword v56, v61, s[52:55], s69 offen sc1
    s_mov_b32 exec_hi, -1
    s_waitcnt lgkmcnt(2)
    v_mfma_f32_16x16x32_bf16 v[236:239], a[224:227], v[164:167], v[236:239]
    ds_read_b128 v[144:147], v58 offset:768
    v_mfma_f32_16x16x32_bf16 v[244:247], a[224:227], v[168:171], v[244:247]
    v_cmp_ne_u32 vcc, -1, v3
    s_nop 0
    s_cbranch_vccnz L_slow_7
L_ok_8:
    v_mfma_f32_16x16x32_bf16 v[220:223], a[224:227], v[156:159], v[220:223]
    ds_read_b64_tr_b16 a[240:241], v57 offset:552
    v_mfma_f32_16x16x32_bf16 v[228:231], a[224:227], v[160:163], v[228:231]
    buffer_load_dwordx4 a[112:115], v70, s[52:55], s13 offen offset:0 sc1
    v_mfma_f32_16x16x32_bf16 v[236:239], a[228:231], v[156:159], v[236:239]
    ds_read_b64_tr_b16 a[242:243], v57 offset:520
    ds_read_b64_tr_b16 a[244:245], v57 offset:1576
    v_mfma_f32_16x16x32_bf16 v[244:247], a[228:231], v[160:163], v[244:247]
    ds_read_b64_tr_b16 a[246:247], v57 offset:1544
    s_waitcnt lgkmcnt(5)
    v_mfma_f32_16x16x32_bf16 v[204:207], a[224:227], v[148:151], v[204:207]
    ds_read_b64_tr_b16 a[248:249], v57 offset:2600
    v_mfma_f32_16x16x32_bf16 v[212:215], a[224:227], v[152:155], v[212:215]
    buffer_load_dwordx4 a[116:119], v71, s[52:55], s13 offen offset:0 sc1
    v_mfma_f32_16x16x32_bf16 v[220:223], a[228:231], v[148:151], v[220:223]
    ds_read_b64_tr_b16 a[250:251], v57 offset:2568
    v_mfma_f32_16x16x32_bf16 v[228:231], a[228:231], v[152:155], v[228:231]
    ds_read_b64_tr_b16 a[252:253], v57 offset:3624
    v_mfma_f32_16x16x32_bf16 v[236:239], a[232:235], v[148:151], v[236:239]
    ds_read_b64_tr_b16 a[254:255], v57 offset:3592
    v_mfma_f32_16x16x32_bf16 v[244:247], a[232:235], v[152:155], v[244:247]
    buffer_load_dwordx4 a[120:123], v70, s[52:55], s13 offen offset:1024 sc1
    s_waitcnt lgkmcnt(8)
    v_mfma_f32_16x16x32_bf16 v[196:199], a[224:227], v[144:147], v[196:199]
    buffer_load_dwordx4 a[124:127], v71, s[52:55], s13 offen offset:1024 sc1
    v_mfma_f32_16x16x32_bf16 v[212:215], a[228:231], v[144:147], v[212:215]
    s_waitcnt lgkmcnt(0)
L_pad4:
    s_cbranch_execz L_ret
    s_nop 0
    v_mfma_f32_16x16x32_bf16 v[228:231], a[232:235], v[144:147], v[228:231]
    ds_read_b64_tr_b16 a[224:225], v57 offset:800
    v_mfma_f32_16x16x32_bf16 v[244:247], a[236:239], v[144:147], v[244:247]
    ds_read_b64_tr_b16 a[226:227], v57 offset:768
    v_mfma_f32_16x16x32_bf16 v[240:243], a[240:243], v[164:167], v[240:243]
    ds_read_b64_tr_b16 a[228:229], v57 offset:1824
    v_mfma_f32_16x16x32_bf16 v[248:251], a[240:243], v[168:171], v[248:251]
    ds_read_b64_tr_b16 a[230:231], v57 offset:1792
    v_mfma_f32_16x16x32_bf16 v[224:227], a[240:243], v[156:159], v[224:227]
    buffer_load_dwordx4 a[128:131], v70, s[52:55], s14 offen offset:0 sc1
    v_mfma_f32_16x16x32_bf16 v[232:235], a[240:243], v[160:163], v[232:235]
    ds_read_b64_tr_b16 a[232:233], v57 offset:2848
    v_mfma_f32_16x16x32_bf16 v[240:243], a[244:247], v[156:159], v[240:243]
    ds_read_b128 v[164:167], v58 offset:3072
    v_mfma_f32_16x16x32_bf16 v[248:251], a[244:247], v[160:163], v[248:251]
    ds_read_b128 v[168:171], v58 offset:3584
    v_mfma_f32_16x16x32_bf16 v[208:211], a[240:243], v[148:151], v[208:211]
    ds_read_b64_tr_b16 a[234:235], v57 offset:2816
    v_mfma_f32_16x16x32_bf16 v[216:219], a[240:243], v[152:155], v[216:219]
    buffer_load_dwordx4 a[132:135], v71, s[52:55], s14 offen offset:0 sc1
    v_mfma_f32_16x16x32_bf16 v[224:227], a[244:247], v[148:151], v[224:227]
    ds_read_b64_tr_b16 a[236:237], v57 offset:3872
    v_mfma_f32_16x16x32_bf16 v[232:235], a[244:247], v[152:155], v[232:235]
    ds_read_b128 v[156:159], v58 offset:2048
    v_mfma_f32_16x16x32_bf16 v[240:243], a[248:251], v[148:151], v[240:243]
    ds_read_b128 v[160:163], v58 offset:2560
    v_mfma_f32_16x16x32_bf16 v[248:251], a[248:251], v[152:155], v[248:251]
    ds_read_b64_tr_b16 a[238:239], v57 offset:3840
    v_mfma_f32_16x16x32_bf16 v[200:203], a[240:243], v[144:147], v[200:203]
    buffer_load_dwordx4 a[136:139], v70, s[52:55], s14 offen offset:1024 sc1
    v_mfma_f32_16x16x32_bf16 v[216:219], a[244:247], v[144:147], v[216:219]
    ds_read_b128 v[148:151], v58 offset:1024
    v_mfma_f32_16x16x32_bf16 v[232:235], a[248:251], v[144:147], v[232:235]
    ds_read_b128 v[152:155], v58 offset:1536
    v_mfma_f32_16x16x32_bf16 v[248:251], a[252:255], v[144:147], v[248:251]
    buffer_load_dwordx4 a[140:143], v71, s[52:55], s14 offen offset:1024 sc1
    s_waitcnt lgkmcnt(2)
    v_mfma_f32_16x16x32_bf16 v[236:239], a[224:227], v[164:167], v[236:239]
    ds_read_b128 v[144:147], v58 offset:512
    v_mfma_f32_16x16x32_bf16 v[244:247], a[224:227], v[168:171], v[244:247]
    ds_read_b64_tr_b16 a[240:241], v57 offset:808
    v_mfma_f32_16x16x32_bf16 v[220:223], a[224:227], v[156:159], v[220:223]
    buffer_load_dwordx4 a[144:147], v70, s[52:55], s15 offen offset:0 sc1
    v_mfma_f32_16x16x32_bf16 v[228:231], a[224:227], v[160:163], v[228:231]
    ds_read_b64_tr_b16 a[242:243], v57 offset:776
    v_mfma_f32_16x16x32_bf16 v[236:239], a[228:231], v[156:159], v[236:239]
    ds_read_b64_tr_b16 a[244:245], v57 offset:1832
    v_mfma_f32_16x16x32_bf16 v[244:247], a[228:231], v[160:163], v[244:247]
    ds_read_b64_tr_b16 a[246:247], v57 offset:1800
    s_waitcnt lgkmcnt(5)
    v_mfma_f32_16x16x32_bf16 v[204:207], a[224:227], v[148:151], v[204:207]
    ds_read_b64_tr_b16 a[248:249], v57 offset:2856
    v_mfma_f32_16x16x32_bf16 v[212:215], a[224:227], v[152:155], v[212:215]
    buffer_load_dwordx4 a[148:151], v71, s[52:55], s15 offen offset:0 sc1
    v_mfma_f32_16x16x32_bf16 v[220:223], a[228:231], v[148:151], v[220:223]
    ds_read_b64_tr_b16 a[250:251], v57 offset:2824
    v_mfma_f32_16x16x32_bf16 v[228:231], a[228:231], v[152:155], v[228:231]
    ds_read_b64_tr_b16 a[252:253], v57 offset:3880
    v_mfma_f32_16x16x32_bf16 v[236:239], a[232:235], v[148:151], v[236:239]
    ds_read_b64_tr_b16 a[254:255], v57 offset:3848
    v_mfma_f32_16x16x32_bf16 v[244:247], a[232:235], v[152:155], v[244:247]
    buffer_load_dwordx4 a[152:155], v70, s[52:55], s15 offen offset:1024 sc1
    s_waitcnt lgkmcnt(8)
    v_mfma_f32_16x16x32_bf16 v[196:199], a[224:227], v[144:147], v[196:199]
    s_mov_b32 s84, 0x55555555
    v_mfma_f32_16x16x32_bf16 v[212:215], a[228:231], v[144:147], v[212:215]
    s_mov_b32 s85, 0x55555555
    s_mov_b32 s86, 0x33333333
    v_mfma_f32_16x16x32_bf16 v[228:231], a[232:235], v[144:147], v[228:231]
    buffer_load_dwordx4 a[156:159], v71, s[52:55], s15 offen offset:1024 sc1
    v_mfma_f32_16x16x32_bf16 v[244:247], a[236:239], v[144:147], v[244:247]
    s_mov_b32 s87, 0x33333333
    s_waitcnt lgkmcnt(0)
    v_mfma_f32_16x16x32_bf16 v[200:203], a[240:243], v[144:147], v[200:203]
    v_cmp_ne_u32 s[20:21], 0, v59
    v_mfma_f32_16x16x32_bf16 v[208:211], a[240:243], v[148:151], v[208:211]
    buffer_load_dwordx4 a[160:163], v70, s[52:55], s16 offen offset:0 sc1
    v_mfma_f32_16x16x32_bf16 v[216:219], a[240:243], v[152:155], v[216:219]
    s_mul_i32 s69, s66, 4112
    s_add_u32 s69, s69, 18432
    v_lshl_add_u32 v22, v59, 4, s69
    v_mfma_f32_16x16x32_bf16 v[216:219], a[244:247], v[144:147], v[216:219]
    v_cndmask_b32 v24, 0, v22, s[20:21]
    v_mfma_f32_16x16x32_bf16 v[224:227], a[240:243], v[156:159], v[224:227]
    buffer_load_dwordx4 a[164:167], v71, s[52:55], s16 offen offset:0 sc1
    v_mfma_f32_16x16x32_bf16 v[232:235], a[240:243], v[160:163], v[232:235]
    buffer_load_dwordx4 a[168:171], v70, s[52:55], s16 offen offset:1024 sc1
    v_mfma_f32_16x16x32_bf16 v[224:227], a[244:247], v[148:151], v[224:227]
    v_mov_b32_dpp v8, v195 row_shl:4 row_mask:0xf bank_mask:0x5
    v_mfma_f32_16x16x32_bf16 v[232:235], a[244:247], v[152:155], v[232:235]
    v_add_f32_dpp v195, v194, v195 row_shl:4 row_mask:0xf bank_mask:0x5
    v_add_f32_dpp v194, v193, v194 row_shl:4 row_mask:0xf bank_mask:0x5
    v_mfma_f32_16x16x32_bf16 v[232:235], a[248:251], v[144:147], v[232:235]
    v_add_f32_dpp v193, v192, v193 row_shl:4 row_mask:0xf bank_mask:0x5
    v_add_f32_dpp v192, v191, v192 row_shl:4 row_mask:0xf bank_mask:0x5
    v_add_f32_dpp v191, v190, v191 row_shl:4 row_mask:0xf bank_mask:0x5
    v_add_f32_dpp v190, v189, v190 row_shl:4 row_mask:0xf bank_mask:0x5
    v_mfma_f32_16x16x32_bf16 v[240:243], a[240:243], v[164:167], v[240:243]
    buffer_load_dwordx4 a[172:175], v71, s[52:55], s16 offen offset:1024 sc1
    v_add_f32_dpp v189, v188, v189 row_shl:4 row_mask:0xf bank_mask:0x5
    v_mov_b32_dpp v8, v211 quad_perm:[0,1,2,3] row_mask:0xf bank_mask:0xa
    v_add_f32_dpp v195, v211, v210 row_shr:4 row_mask:0xf bank_mask:0xa
    v_mfma_f32_16x16x32_bf16 v[248:251], a[240:243], v[168:171], v[248:251]
    v_add_f32_dpp v194, v210, v209 row_shr:4 row_mask:0xf bank_mask:0xa
    v_add_f32_dpp v193, v209, v208 row_shr:4 row_mask:0xf bank_mask:0xa
    v_add_f32_dpp v192, v208, v207 row_shr:4 row_mask:0xf bank_mask:0xa
    v_add_f32_dpp v191, v207, v206 row_shr:4 row_mask:0xf bank_mask:0xa
    v_mfma_f32_16x16x32_bf16 v[240:243], a[244:247], v[156:159], v[240:243]
    buffer_load_dwordx4 a[176:179], v70, s[52:55], s17 offen offset:0 sc1
    v_add_f32_dpp v190, v206, v205 row_shr:4 row_mask:0xf bank_mask:0xa
    v_add_f32_dpp v189, v205, v204 row_shr:4 row_mask:0xf bank_mask:0xa
    v_mov_b32_dpp v188, v204 row_shr:4 row_mask:0xf bank_mask:0xa
    v_mfma_f32_16x16x32_bf16 v[248:251], a[244:247], v[160:163], v[248:251]
    v_mov_b32_dpp v16, v203 row_shl:4 row_mask:0xf bank_mask:0x5
    v_add_f32_dpp v203, v202, v203 row_shl:4 row_mask:0xf bank_mask:0x5
    v_add_f32_dpp v202, v201, v202 row_shl:4 row_mask:0xf bank_mask:0x5
    v_add_f32_dpp v201, v200, v201 row_shl:4 row_mask:0xf bank_mask:0x5
    v_mfma_f32_16x16x32_bf16 v[240:243], a[248:251], v[148:151], v[240:243]
    buffer_load_dwordx4 a[180:183], v71, s[52:55], s17 offen offset:0 sc1
    v_add_f32_dpp v200, v199, v200 row_shl:4 row_mask:0xf bank_mask:0x5
    v_add_f32_dpp v199, v198, v199 row_shl:4 row_mask:0xf bank_mask:0x5
    v_add_f32_dpp v198, v197, v198 row_shl:4 row_mask:0xf bank_mask:0x5
    v_mfma_f32_16x16x32_bf16 v[248:251], a[248:251], v[152:155], v[248:251]
    v_add_f32_dpp v197, v196, v197 row_shl:4 row_mask:0xf bank_mask:0x5
    v_mov_b32_dpp v16, v219 quad_perm:[0,1,2,3] row_mask:0xf bank_mask:0xa
    v_add_f32_dpp v203, v219, v218 row_shr:4 row_mask:0xf bank_mask:0xa
    s_nop 0
    s_waitcnt vmcnt(14)
    v_mfma_f32_16x16x32_bf16 v[248:251], a[252:255], v[144:147], v[248:251]
    v_add_f32_dpp v202, v218, v217 row_shr:4 row_mask:0xf bank_mask:0xa
    v_add_f32_dpp v201, v217, v216 row_shr:4 row_mask:0xf bank_mask:0xa
    v_add_f32_dpp v200, v216, v215 row_shr:4 row_mask:0xf bank_mask:0xa
    v_add_f32_dpp v199, v215, v214 row_shr:4 row_mask:0xf bank_mask:0xa
    v_mfma_f32_16x16x32_bf16 v[76:79], a[0:3], a[112:115], 0
    v_add_f32_dpp v198, v214, v213 row_shr:4 row_mask:0xf bank_mask:0xa
    v_add_f32_dpp v197, v213, v212 row_shr:4 row_mask:0xf bank_mask:0xa
    v_mov_b32_dpp v196, v212 row_shr:4 row_mask:0xf bank_mask:0xa
    v_mov_b32_dpp v20, v227 row_shl:4 row_mask:0xf bank_mask:0x5
    v_mfma_f32_16x16x32_bf16 v[84:87], a[0:3], a[120:123], 0
    buffer_load_dwordx4 a[184:187], v70, s[52:55], s17 offen offset:1024 sc1
    v_add_f32_dpp v227, v226, v227 row_shl:4 row_mask:0xf bank_mask:0x5
    v_add_f32_dpp v226, v225, v226 row_shl:4 row_mask:0xf bank_mask:0x5
    v_add_f32_dpp v225, v224, v225 row_shl:4 row_mask:0xf bank_mask:0x5
    v_mfma_f32_16x16x32_bf16 v[92:95], a[4:7], a[112:115], 0
    v_add_f32_dpp v224, v223, v224 row_shl:4 row_mask:0xf bank_mask:0x5
    v_add_f32_dpp v223, v222, v223 row_shl:4 row_mask:0xf bank_mask:0x5
    v_add_f32_dpp v222, v221, v222 row_shl:4 row_mask:0xf bank_mask:0x5
    v_add_f32_dpp v221, v220, v221 row_shl:4 row_mask:0xf bank_mask:0x5
    v_mfma_f32_16x16x32_bf16 v[100:103], a[4:7], a[120:123], 0
    buffer_load_dwordx4 a[188:191], v71, s[52:55], s17 offen offset:1024 sc1
    v_mov_b32_dpp v20, v243 quad_perm:[0,1,2,3] row_mask:0xf bank_mask:0xa
    v_add_f32_dpp v227, v243, v242 row_shr:4 row_mask:0xf bank_mask:0xa
    v_add_f32_dpp v226, v242, v241 row_shr:4 row_mask:0xf bank_mask:0xa
    v_mfma_f32_16x16x32_bf16 v[108:111], a[0:3], a[116:119], 0
    v_add_f32_dpp v225, v241, v240 row_shr:4 row_mask:0xf bank_mask:0xa
    v_add_f32_dpp v224, v240, v239 row_shr:4 row_mask:0xf bank_mask:0xa
    v_add_f32_dpp v223, v239, v238 row_shr:4 row_mask:0xf bank_mask:0xa
    v_add_f32_dpp v222, v238, v237 row_shr:4 row_mask:0xf bank_mask:0xa
    v_mfma_f32_16x16x32_bf16 v[116:119], a[0:3], a[124:127], 0
    buffer_load_dwordx4 a[192:195], v70, s[52:55], s18 offen offset:0 sc1
    v_add_f32_dpp v221, v237, v236 row_shr:4 row_mask:0xf bank_mask:0xa
    v_mov_b32_dpp v220, v236 row_shr:4 row_mask:0xf bank_mask:0xa
    v_mov_b32_dpp v21, v235 row_shl:4 row_mask:0xf bank_mask:0x5
    v_mfma_f32_16x16x32_bf16 v[124:127], a[4:7], a[116:119], 0
    v_add_f32_dpp v235, v234, v235 row_shl:4 row_mask:0xf bank_mask:0x5
    v_add_f32_dpp v234, v233, v234 row_shl:4 row_mask:0xf bank_mask:0x5
    v_add_f32_dpp v233, v232, v233 row_shl:4 row_mask:0xf bank_mask:0x5
    v_add_f32_dpp v232, v231, v232 row_shl:4 row_mask:0xf bank_mask:0x5
    v_mfma_f32_16x16x32_bf16 v[132:135], a[4:7], a[124:127], 0
    v_add_f32_dpp v231, v230, v231 row_shl:4 row_mask:0xf bank_mask:0x5
    v_add_f32_dpp v230, v229, v230 row_shl:4 row_mask:0xf bank_mask:0x5
    v_add_f32_dpp v229, v228, v229 row_shl:4 row_mask:0xf bank_mask:0x5
    v_mov_b32_dpp v21, v251 quad_perm:[0,1,2,3] row_mask:0xf bank_mask:0xa
    v_mfma_f32_16x16x32_bf16 v[80:83], a[8:11], a[112:115], 0
    v_add_f32_dpp v235, v251, v250 row_shr:4 row_mask:0xf bank_mask:0xa
    v_add_f32_dpp v234, v250, v249 row_shr:4 row_mask:0xf bank_mask:0xa
    v_add_f32_dpp v233, v249, v248 row_shr:4 row_mask:0xf bank_mask:0xa
    v_add_f32_dpp v232, v248, v247 row_shr:4 row_mask:0xf bank_mask:0xa
    v_mfma_f32_16x16x32_bf16 v[88:91], a[8:11], a[120:123], 0
    buffer_load_dwordx4 a[196:199], v71, s[52:55], s18 offen offset:0 sc1
    v_add_f32_dpp v231, v247, v246 row_shr:4 row_mask:0xf bank_mask:0xa
    v_add_f32_dpp v230, v246, v245 row_shr:4 row_mask:0xf bank_mask:0xa
    v_add_f32_dpp v229, v245, v244 row_shr:4 row_mask:0xf bank_mask:0xa
    v_mfma_f32_16x16x32_bf16 v[96:99], a[12:15], a[112:115], 0
    v_mov_b32_dpp v228, v244 row_shr:4 row_mask:0xf bank_mask:0xa
    v_mov_b32_dpp v10, v8 row_shl:8 row_mask:0xf bank_mask:0x3
    v_mov_b32_dpp v9, v195 row_shl:8 row_mask:0xf bank_mask:0x3
    v_add_f32_dpp v8, v194, v8 row_shl:8 row_mask:0xf bank_mask:0x3
    v_mfma_f32_16x16x32_bf16 v[104:107], a[12:15], a[120:123], 0
    buffer_load_dwordx4 a[200:203], v70, s[52:55], s18 offen offset:1024 sc1
    v_mov_b32_dpp v10, v20 quad_perm:[0,1,2,3] row_mask:0xf bank_mask:0xc
    v_mov_b32_dpp v9, v227 quad_perm:[0,1,2,3] row_mask:0xf bank_mask:0xc
    v_add_f32_dpp v8, v20, v226 row_shr:8 row_mask:0xf bank_mask:0xc
    v_mfma_f32_16x16x32_bf16 v[112:115], a[8:11], a[116:119], 0
    v_mov_b32_dpp v18, v16 row_shl:8 row_mask:0xf bank_mask:0x3
    v_mov_b32_dpp v17, v203 row_shl:8 row_mask:0xf bank_mask:0x3
    v_add_f32_dpp v16, v202, v16 row_shl:8 row_mask:0xf bank_mask:0x3
    v_mov_b32_dpp v18, v21 quad_perm:[0,1,2,3] row_mask:0xf bank_mask:0xc
    v_mfma_f32_16x16x32_bf16 v[120:123], a[8:11], a[124:127], 0
    buffer_load_dwordx4 a[204:207], v71, s[52:55], s18 offen offset:1024 sc1
    v_mov_b32_dpp v17, v235 quad_perm:[0,1,2,3] row_mask:0xf bank_mask:0xc
    v_add_f32_dpp v16, v21, v234 row_shr:8 row_mask:0xf bank_mask:0xc
    v_mfma_f32_16x16x32_bf16 v[128:131], a[12:15], a[116:119], 0
    ds_write_b128 v22, v[8:11] offset:16
    v_mfma_f32_16x16x32_bf16 v[136:139], a[12:15], a[124:127], 0
    s_nop 0
    s_waitcnt vmcnt(16)
    buffer_load_dword v3, v63, s[52:55], 0 offen sc1
    v_mfma_f32_16x16x32_bf16 v[76:79], a[16:19], a[128:131], v[76:79]
    ds_write_b128 v22, v[16:19] offset:528
    v_mfma_f32_16x16x32_bf16 v[84:87], a[16:19], a[136:139], v[84:87]
    v_add_f32_dpp v195, v193, v195 row_shl:8 row_mask:0xf bank_mask:0x3
    v_add_f32_dpp v194, v192, v194 row_shl:8 row_mask:0xf bank_mask:0x3
    v_add_f32_dpp v193, v191, v193 row_shl:8 row_mask:0xf bank_mask:0x3
    v_mfma_f32_16x16x32_bf16 v[92:95], a[20:23], a[128:131], v[92:95]
    buffer_load_dwordx4 a[208:211], v70, s[52:55], s19 offen offset:0 sc1
    v_add_f32_dpp v192, v190, v192 row_shl:8 row_mask:0xf bank_mask:0x3
    v_add_f32_dpp v191, v189, v191 row_shl:8 row_mask:0xf bank_mask:0x3
    v_add_f32_dpp v190, v188, v190 row_shl:8 row_mask:0xf bank_mask:0x3
    v_mfma_f32_16x16x32_bf16 v[100:103], a[20:23], a[136:139], v[100:103]
    v_add_f32_dpp v195, v227, v225 row_shr:8 row_mask:0xf bank_mask:0xc
    v_add_f32_dpp v194, v226, v224 row_shr:8 row_mask:0xf bank_mask:0xc
    v_add_f32_dpp v193, v225, v223 row_shr:8 row_mask:0xf bank_mask:0xc
    v_add_f32_dpp v192, v224, v222 row_shr:8 row_mask:0xf bank_mask:0xc
    v_mfma_f32_16x16x32_bf16 v[108:111], a[16:19], a[132:135], v[108:111]
    buffer_load_dwordx4 a[212:215], v71, s[52:55], s19 offen offset:0 sc1
    v_add_f32_dpp v191, v223, v221 row_shr:8 row_mask:0xf bank_mask:0xc
    v_add_f32_dpp v190, v222, v220 row_shr:8 row_mask:0xf bank_mask:0xc
    v_mov_b32_dpp v189, v221 row_shr:8 row_mask:0xf bank_mask:0xc
    v_mfma_f32_16x16x32_bf16 v[116:119], a[16:19], a[140:143], v[116:119]
    v_mov_b32_dpp v188, v220 row_shr:8 row_mask:0xf bank_mask:0xc
    v_add_f32_dpp v203, v201, v203 row_shl:8 row_mask:0xf bank_mask:0x3
    v_add_f32_dpp v202, v200, v202 row_shl:8 row_mask:0xf bank_mask:0x3
    v_add_f32_dpp v201, v199, v201 row_shl:8 row_mask:0xf bank_mask:0x3
    v_mfma_f32_16x16x32_bf16 v[124:127], a[20:23], a[132:135], v[124:127]
    buffer_load_dwordx4 a[216:219], v70, s[52:55], s19 offen offset:1024 sc1
    v_add_f32_dpp v200, v198, v200 row_shl:8 row_mask:0xf bank_mask:0x3
    v_mfma_f32_16x16x32_bf16 v[132:135], a[20:23], a[140:143], v[132:135]
    s_waitcnt lgkmcnt(0)
    s_barrier
    ds_read_b128 v[8:11], v24
    v_mfma_f32_16x16x32_bf16 v[80:83], a[24:27], a[128:131], v[80:83]
    ds_read_b128 v[16:19], v22 offset:512
    v_add_f32_dpp v199, v197, v199 row_shl:8 row_mask:0xf bank_mask:0x3
    v_add_f32_dpp v198, v196, v198 row_shl:8 row_mask:0xf bank_mask:0x3
    v_mfma_f32_16x16x32_bf16 v[88:91], a[24:27], a[136:139], v[88:91]
    buffer_load_dwordx4 a[220:223], v71, s[52:55], s19 offen offset:1024 sc1
    v_add_f32_dpp v203, v235, v233 row_shr:8 row_mask:0xf bank_mask:0xc
    v_add_f32_dpp v202, v234, v232 row_shr:8 row_mask:0xf bank_mask:0xc
    v_add_f32_dpp v201, v233, v231 row_shr:8 row_mask:0xf bank_mask:0xc
    v_mfma_f32_16x16x32_bf16 v[96:99], a[28:31], a[128:131], v[96:99]
    v_add_f32_dpp v200, v232, v230 row_shr:8 row_mask:0xf bank_mask:0xc
    v_add_f32_dpp v199, v231, v229 row_shr:8 row_mask:0xf bank_mask:0xc
    v_add_f32_dpp v198, v230, v228 row_shr:8 row_mask:0xf bank_mask:0xc
    v_mov_b32_dpp v197, v229 row_shr:8 row_mask:0xf bank_mask:0xc
    v_mfma_f32_16x16x32_bf16 v[104:107], a[28:31], a[136:139], v[104:107]
    v_mov_b32_dpp v196, v228 row_shr:8 row_mask:0xf bank_mask:0xc
    v_cvt_pk_bf16_f32 v206, v192, v193
    v_cvt_pk_bf16_f32 v207, v194, v195
    v_mfma_f32_16x16x32_bf16 v[112:115], a[24:27], a[132:135], v[112:115]
    v_cvt_pk_bf16_f32 v210, v200, v201
    v_cvt_pk_bf16_f32 v211, v202, v203
    s_waitcnt lgkmcnt(1)
    v_mfma_f32_16x16x32_bf16 v[120:123], a[24:27], a[140:143], v[120:123]
    v_add_f32 v188, v188, v8
    v_add_f32 v189, v189, v9
    v_add_f32 v190, v190, v10
    v_mfma_f32_16x16x32_bf16 v[128:131], a[28:31], a[132:135], v[128:131]
    v_cvt_pk_bf16_f32 v204, v188, v189
    v_cvt_pk_bf16_f32 v205, v190, v191
    v_mfma_f32_16x16x32_bf16 v[136:139], a[28:31], a[140:143], v[136:139]
    s_waitcnt lgkmcnt(0)
    v_add_f32 v196, v196, v16
    s_waitcnt vmcnt(17)
    v_mfma_f32_16x16x32_bf16 v[76:79], a[32:35], a[144:147], v[76:79]
    v_add_f32 v197, v197, v17
    v_mfma_f32_16x16x32_bf16 v[84:87], a[32:35], a[152:155], v[84:87]
    v_add_f32_e64 v198, v198, v18
    v_mfma_f32_16x16x32_bf16 v[92:95], a[36:39], a[144:147], v[92:95]
    v_cvt_pk_bf16_f32 v208, v196, v197
    v_mfma_f32_16x16x32_bf16 v[100:103], a[36:39], a[152:155], v[100:103]
    v_cvt_pk_bf16_f32 v209, v198, v199
    v_mfma_f32_16x16x32_bf16 v[108:111], a[32:35], a[148:151], v[108:111]
    buffer_store_dwordx4 v[204:207], v23, s[52:55], 0 offen sc1
    v_mfma_f32_16x16x32_bf16 v[116:119], a[32:35], a[156:159], v[116:119]
    buffer_store_dwordx4 v[208:211], v23, s[52:55], 0 offen offset:512 sc1
    v_mfma_f32_16x16x32_bf16 v[124:127], a[36:39], a[148:151], v[124:127]
    v_mfma_f32_16x16x32_bf16 v[132:135], a[36:39], a[156:159], v[132:135]
    v_mfma_f32_16x16x32_bf16 v[80:83], a[40:43], a[144:147], v[80:83]
    s_waitcnt vmcnt(6)
    v_mfma_f32_16x16x32_bf16 v[88:91], a[40:43], a[152:155], v[88:91]
    v_cmp_ne_u32 vcc, -1, v3
    s_nop 0
    s_cbranch_vccnz L_slow_10
L_ok_11:
    v_mfma_f32_16x16x32_bf16 v[96:99], a[44:47], a[144:147], v[96:99]
    v_bfe_u32 v220, v1, 2, 2
    v_add_u32 v70, 114688, v70
    v_mfma_f32_16x16x32_bf16 v[104:107], a[44:47], a[152:155], v[104:107]
    v_add_u32 v71, 114688, v71
    v_mfma_f32_16x16x32_bf16 v[112:115], a[40:43], a[148:151], v[112:115]
    buffer_load_dwordx4 a[112:115], v70, s[52:55], s13 offen offset:0 sc1
    v_mfma_f32_16x16x32_bf16 v[120:123], a[40:43], a[156:159], v[120:123]
    v_and_b32 v60, 0xffffffef, v64
    v_lshlrev_b32_e64 v60, 3, v60
    s_mov_b32 s69, 12582912
    buffer_load_dwordx2 v[4:5], v60, s[52:55], s69 offen sc1
    buffer_load_dwordx2 v[6:7], v60, s[52:55], s69 offen offset:128 sc1
    v_mfma_f32_16x16x32_bf16 v[128:131], a[44:47], a[148:151], v[128:131]
    buffer_load_dwordx4 a[116:119], v71, s[52:55], s13 offen offset:0 sc1
    v_mfma_f32_16x16x32_bf16 v[136:139], a[44:47], a[156:159], v[136:139]
    v_and_b32_e64 v223, 3, v1
    v_mfma_f32_16x16x32_bf16 v[76:79], a[48:51], a[160:163], v[76:79]
    v_mfma_f32_16x16x32_bf16 v[84:87], a[48:51], a[168:171], v[84:87]
    v_lshl_add_u32 v220, v220, 3, v223
    v_mfma_f32_16x16x32_bf16 v[92:95], a[52:55], a[160:163], v[92:95]
    v_mfma_f32_16x16x32_bf16 v[100:103], a[52:55], a[168:171], v[100:103]
    buffer_load_dwordx4 a[120:123], v70, s[52:55], s13 offen offset:1024 sc1
    v_mfma_f32_16x16x32_bf16 v[108:111], a[48:51], a[164:167], v[108:111]
    v_mfma_f32_16x16x32_bf16 v[116:119], a[48:51], a[172:175], v[116:119]
    v_mfma_f32_16x16x32_bf16 v[124:127], a[52:55], a[164:167], v[124:127]
    v_mfma_f32_16x16x32_bf16 v[132:135], a[52:55], a[172:175], v[132:135]
    buffer_load_dwordx4 a[124:127], v71, s[52:55], s13 offen offset:1024 sc1
    v_mfma_f32_16x16x32_bf16 v[80:83], a[56:59], a[160:163], v[80:83]
    v_mfma_f32_16x16x32_bf16 v[88:91], a[56:59], a[168:171], v[88:91]
    s_lshl1_add_u32 s69, s64, s67
    s_lshl_b32 s69, s69, 9
    s_lshr_b32 s68, s65, 1
    s_add_u32 s69, s69, s68
    s_nop 0
    s_lshl_b32 s69, s69, 8
    v_lshl_add_u32 v220, v220, 12, s69
    v_mfma_f32_16x16x32_bf16 v[96:99], a[60:63], a[160:163], v[96:99]
    v_mfma_f32_16x16x32_bf16 v[104:107], a[60:63], a[168:171], v[104:107]
    buffer_load_dwordx4 a[128:131], v70, s[52:55], s14 offen offset:0 sc1
    v_mfma_f32_16x16x32_bf16 v[112:115], a[56:59], a[164:167], v[112:115]
    v_mfma_f32_16x16x32_bf16 v[120:123], a[56:59], a[172:175], v[120:123]
    v_mfma_f32_16x16x32_bf16 v[128:131], a[60:63], a[164:167], v[128:131]
    buffer_load_dwordx4 a[132:135], v71, s[52:55], s14 offen offset:0 sc1
    v_mfma_f32_16x16x32_bf16 v[136:139], a[60:63], a[172:175], v[136:139]
    v_mfma_f32_16x16x32_bf16 v[76:79], a[64:67], a[176:179], v[76:79]
    ds_read_b64_tr_b16 a[0:1], v53 offset:49152
    v_mfma_f32_16x16x32_bf16 v[84:87], a[64:67], a[184:187], v[84:87]
    ds_read_b64_tr_b16 a[2:3], v53 offset:51200
    v_mfma_f32_16x16x32_bf16 v[92:95], a[68:71], a[176:179], v[92:95]
    buffer_load_dwordx4 a[136:139], v70, s[52:55], s14 offen offset:1024 sc1
    v_mfma_f32_16x16x32_bf16 v[100:103], a[68:71], a[184:187], v[100:103]
    s_and_b32 s68, s65, 1
    s_lshl1_add_u32 s68, s68, s66
    s_lshl_b32 s68, s68, 0
    s_lshl4_add_u32 s68, s68, 10485760
    v_add_u32 v220, s68, v220
    v_mfma_f32_16x16x32_bf16 v[108:111], a[64:67], a[180:183], v[108:111]
    v_lshrrev_b32_e64 v223, 4, v1
    v_mfma_f32_16x16x32_bf16 v[116:119], a[64:67], a[188:191], v[116:119]
    ds_read_b64_tr_b16 a[4:5], v55 offset:49152
    v_mfma_f32_16x16x32_bf16 v[124:127], a[68:71], a[180:183], v[124:127]
    ds_read_b64_tr_b16 a[6:7], v55 offset:51200
    v_lshl_add_u32 v220, v223, 6, v220
    v_mfma_f32_16x16x32_bf16 v[132:135], a[68:71], a[188:191], v[132:135]
    buffer_load_dwordx4 a[140:143], v71, s[52:55], s14 offen offset:1024 sc1
    v_add_u32 v221, 16384, v220
    v_mfma_f32_16x16x32_bf16 v[80:83], a[72:75], a[176:179], v[80:83]
    ds_read_b64_tr_b16 a[8:9], v53 offset:49160
    v_mfma_f32_16x16x32_bf16 v[88:91], a[72:75], a[184:187], v[88:91]
    ds_read_b64_tr_b16 a[10:11], v53 offset:51208
    v_bfe_u32 v225, v1, 1, 3
    v_mfma_f32_16x16x32_bf16 v[96:99], a[76:79], a[176:179], v[96:99]
    buffer_load_dwordx4 a[144:147], v70, s[52:55], s15 offen offset:0 sc1
    v_mfma_f32_16x16x32_bf16 v[104:107], a[76:79], a[184:187], v[104:107]
    v_lshlrev_b32_e64 v224, 2, v223
    v_mfma_f32_16x16x32_bf16 v[112:115], a[72:75], a[180:183], v[112:115]
    ds_read_b64_tr_b16 a[12:13], v55 offset:49160
    v_mfma_f32_16x16x32_bf16 v[120:123], a[72:75], a[188:191], v[120:123]
    ds_read_b64_tr_b16 a[14:15], v55 offset:51208
    v_sub_u32_e64 v225, v225, v224
    v_mfma_f32_16x16x32_bf16 v[128:131], a[76:79], a[180:183], v[128:131]
    buffer_load_dwordx4 a[148:151], v71, s[52:55], s15 offen offset:0 sc1
    v_mfma_f32_16x16x32_bf16 v[136:139], a[76:79], a[188:191], v[136:139]
    v_add_u32_e64 v222, s70, v2
    v_mfma_f32_16x16x32_bf16 v[76:79], a[80:83], a[192:195], v[76:79]
    ds_read_b64_tr_b16 a[16:17], v52 offset:49152
    v_mfma_f32_16x16x32_bf16 v[84:87], a[80:83], a[200:203], v[84:87]
    ds_read_b64_tr_b16 a[18:19], v52 offset:51200
    v_mfma_f32_16x16x32_bf16 v[92:95], a[84:87], a[192:195], v[92:95]
    buffer_load_dwordx4 a[152:155], v70, s[52:55], s15 offen offset:1024 sc1
    v_mfma_f32_16x16x32_bf16 v[100:103], a[84:87], a[200:203], v[100:103]
    v_lshrrev_b32_e64 v223, 5, v1
    v_mfma_f32_16x16x32_bf16 v[108:111], a[80:83], a[196:199], v[108:111]
    ds_read_b64_tr_b16 a[20:21], v54 offset:49152
    v_mfma_f32_16x16x32_bf16 v[116:119], a[80:83], a[204:207], v[116:119]
    ds_read_b64_tr_b16 a[22:23], v54 offset:51200
    v_xor_b32 v226, 4096, v222
    v_mfma_f32_16x16x32_bf16 v[124:127], a[84:87], a[196:199], v[124:127]
    buffer_load_dwordx4 a[156:159], v71, s[52:55], s15 offen offset:1024 sc1
    v_mfma_f32_16x16x32_bf16 v[132:135], a[84:87], a[204:207], v[132:135]
    v_add_u32 v226, 147456, v226
    v_mfma_f32_16x16x32_bf16 v[80:83], a[88:91], a[192:195], v[80:83]
    ds_read_b64_tr_b16 a[24:25], v52 offset:49160
    v_mfma_f32_16x16x32_bf16 v[88:91], a[88:91], a[200:203], v[88:91]
    ds_read_b64_tr_b16 a[26:27], v52 offset:51208
    v_add_u32 v229, 147456, v222
    v_mfma_f32_16x16x32_bf16 v[96:99], a[92:95], a[192:195], v[96:99]
    buffer_load_dwordx4 a[160:163], v70, s[52:55], s16 offen offset:0 sc1
    v_mfma_f32_16x16x32_bf16 v[104:107], a[92:95], a[200:203], v[104:107]
    v_xor_b32 v227, 8192, v222
    v_add_u32 v227, 81920, v227
    v_mfma_f32_16x16x32_bf16 v[112:115], a[88:91], a[196:199], v[112:115]
    ds_read_b64_tr_b16 a[28:29], v54 offset:49160
    v_mfma_f32_16x16x32_bf16 v[120:123], a[88:91], a[204:207], v[120:123]
    ds_read_b64_tr_b16 a[30:31], v54 offset:51208
    v_mfma_f32_16x16x32_bf16 v[128:131], a[92:95], a[196:199], v[128:131]
    buffer_load_dwordx4 a[164:167], v71, s[52:55], s16 offen offset:0 sc1
    v_mfma_f32_16x16x32_bf16 v[136:139], a[92:95], a[204:207], v[136:139]
    v_add_u32 v230, 81920, v222
    s_nop 0
    s_waitcnt vmcnt(18)
    v_mfma_f32_16x16x32_bf16 v[76:79], a[96:99], a[208:211], v[76:79]
    ds_read_b64_tr_b16 a[32:33], v53 offset:0
    v_mfma_f32_16x16x32_bf16 v[84:87], a[96:99], a[216:219], v[84:87]
    ds_read_b64_tr_b16 a[34:35], v53 offset:2048
    v_mfma_f32_16x16x32_bf16 v[92:95], a[100:103], a[208:211], v[92:95]
    v_xor_b32 v228, 12288, v222
    v_mfma_f32_16x16x32_bf16 v[100:103], a[100:103], a[216:219], v[100:103]
    buffer_load_dwordx4 a[168:171], v70, s[52:55], s16 offen offset:1024 sc1
    v_mfma_f32_16x16x32_bf16 v[108:111], a[96:99], a[212:215], v[108:111]
    v_add_u32 v228, 98304, v228
    v_mfma_f32_16x16x32_bf16 v[116:119], a[96:99], a[220:223], v[116:119]
    ds_read_b64_tr_b16 a[36:37], v55 offset:0
    v_mfma_f32_16x16x32_bf16 v[124:127], a[100:103], a[212:215], v[124:127]
    ds_read_b64_tr_b16 a[38:39], v55 offset:2048
    v_mfma_f32_16x16x32_bf16 v[132:135], a[100:103], a[220:223], v[132:135]
    v_add_u32 v231, 98304, v222
    v_mfma_f32_16x16x32_bf16 v[80:83], a[104:107], a[208:211], v[80:83]
    buffer_load_dwordx4 a[172:175], v71, s[52:55], s16 offen offset:1024 sc1
    v_mfma_f32_16x16x32_bf16 v[88:91], a[104:107], a[216:219], v[88:91]
    ds_read_b64_tr_b16 a[40:41], v53 offset:8
    v_mfma_f32_16x16x32_bf16 v[96:99], a[108:111], a[208:211], v[96:99]
    ds_read_b64_tr_b16 a[42:43], v53 offset:2056
    v_mfma_f32_16x16x32_bf16 v[104:107], a[108:111], a[216:219], v[104:107]
    buffer_load_dwordx4 a[176:179], v70, s[52:55], s17 offen offset:0 sc1
    v_mfma_f32_16x16x32_bf16 v[112:115], a[104:107], a[212:215], v[112:115]
    ds_read_b64_tr_b16 a[44:45], v55 offset:8
    v_mfma_f32_16x16x32_bf16 v[120:123], a[104:107], a[220:223], v[120:123]
    ds_read_b64_tr_b16 a[46:47], v55 offset:2056
    v_mfma_f32_16x16x32_bf16 v[128:131], a[108:111], a[212:215], v[128:131]
    buffer_load_dwordx4 a[180:183], v71, s[52:55], s17 offen offset:0 sc1
    v_mfma_f32_16x16x32_bf16 v[136:139], a[108:111], a[220:223], v[136:139]
    s_lshl1_add_u32 s69, s64, s67
    s_lshl_b32 s69, s69, 6
    v_and_b32_e64 v222, -4, v64
    v_mul_u32_u24 v222, 896, v222
    v_add_u32 v222, s69, v222
    s_waitcnt vmcnt(14) lgkmcnt(15)
    v_mfma_f32_16x16x32_bf16 v[76:79], a[0:3], a[112:115], v[76:79]
    ds_read_b64_tr_b16 a[48:49], v53 offset:16384
    v_mfma_f32_16x16x32_bf16 v[84:87], a[0:3], a[120:123], v[84:87]
    ds_read_b64_tr_b16 a[50:51], v53 offset:18432
    v_mul_u32_u24 v223, 896, v223
    v_mfma_f32_16x16x32_bf16 v[92:95], a[4:7], a[112:115], v[92:95]
    buffer_load_dwordx4 a[184:187], v70, s[52:55], s17 offen offset:1024 sc1
    v_mfma_f32_16x16x32_bf16 v[100:103], a[4:7], a[120:123], v[100:103]
    v_add_u32_e64 v222, v223, v222
    v_mfma_f32_16x16x32_bf16 v[108:111], a[0:3], a[116:119], v[108:111]
    ds_read_b64_tr_b16 a[52:53], v55 offset:16384
    v_mfma_f32_16x16x32_bf16 v[116:119], a[0:3], a[124:127], v[116:119]
    ds_read_b64_tr_b16 a[54:55], v55 offset:18432
    v_and_b32_e64 v223, 3, v1
    v_mfma_f32_16x16x32_bf16 v[124:127], a[4:7], a[116:119], v[124:127]
    buffer_load_dwordx4 a[188:191], v71, s[52:55], s17 offen offset:1024 sc1
    v_mfma_f32_16x16x32_bf16 v[132:135], a[4:7], a[124:127], v[132:135]
    v_lshl_add_u32 v222, v223, 4, v222
    v_mfma_f32_16x16x32_bf16 v[80:83], a[8:11], a[112:115], v[80:83]
    ds_read_b64_tr_b16 a[56:57], v53 offset:16392
    v_mfma_f32_16x16x32_bf16 v[88:91], a[8:11], a[120:123], v[88:91]
    ds_read_b64_tr_b16 a[58:59], v53 offset:18440
    v_and_b32_e64 v224, 1, v1
    v_mfma_f32_16x16x32_bf16 v[96:99], a[12:15], a[112:115], v[96:99]
    buffer_load_dwordx4 a[192:195], v70, s[52:55], s18 offen offset:0 sc1
    v_mfma_f32_16x16x32_bf16 v[104:107], a[12:15], a[120:123], v[104:107]
    v_lshlrev_b32_e64 v224, 4, v224
    v_mfma_f32_16x16x32_bf16 v[112:115], a[8:11], a[116:119], v[112:115]
    ds_read_b64_tr_b16 a[60:61], v55 offset:16392
    v_mfma_f32_16x16x32_bf16 v[120:123], a[8:11], a[124:127], v[120:123]
    ds_read_b64_tr_b16 a[62:63], v55 offset:18440
    v_sub_u32 v224, 16, v224
    v_mfma_f32_16x16x32_bf16 v[128:131], a[12:15], a[116:119], v[128:131]
    buffer_load_dwordx4 a[196:199], v71, s[52:55], s18 offen offset:0 sc1
    v_mfma_f32_16x16x32_bf16 v[136:139], a[12:15], a[124:127], v[136:139]
    s_waitcnt vmcnt(14) lgkmcnt(15)
    v_mfma_f32_16x16x32_bf16 v[76:79], a[16:19], a[128:131], v[76:79]
    ds_read_b64_tr_b16 a[64:65], v52 offset:32768
    v_mfma_f32_16x16x32_bf16 v[84:87], a[16:19], a[136:139], v[84:87]
    ds_read_b64_tr_b16 a[66:67], v52 offset:34816
    v_lshrrev_b32_e64 v240, v224, v6
    v_mfma_f32_16x16x32_bf16 v[92:95], a[20:23], a[128:131], v[92:95]
    buffer_load_dwordx4 a[200:203], v70, s[52:55], s18 offen offset:1024 sc1
    v_mfma_f32_16x16x32_bf16 v[100:103], a[20:23], a[136:139], v[100:103]
    v_lshrrev_b32_e64 v224, v224, v4
    v_mfma_f32_16x16x32_bf16 v[108:111], a[16:19], a[132:135], v[108:111]
    ds_read_b64_tr_b16 a[68:69], v54 offset:32768
    v_mfma_f32_16x16x32_bf16 v[116:119], a[16:19], a[140:143], v[116:119]
    ds_read_b64_tr_b16 a[70:71], v54 offset:34816
    v_cmp_eq_u32 s[88:89], 0, v225
    v_mfma_f32_16x16x32_bf16 v[124:127], a[20:23], a[132:135], v[124:127]
    buffer_load_dwordx4 a[204:207], v71, s[52:55], s18 offen offset:1024 sc1
    v_mfma_f32_16x16x32_bf16 v[132:135], a[20:23], a[140:143], v[132:135]
    v_cndmask_b32 v232, 0, v224, s[88:89]
    v_mfma_f32_16x16x32_bf16 v[80:83], a[24:27], a[128:131], v[80:83]
    ds_read_b64_tr_b16 a[72:73], v52 offset:32776
    v_mfma_f32_16x16x32_bf16 v[88:91], a[24:27], a[136:139], v[88:91]
    ds_read_b64_tr_b16 a[74:75], v52 offset:34824
    v_cmp_eq_u32 s[88:89], 1, v225
    v_mfma_f32_16x16x32_bf16 v[96:99], a[28:31], a[128:131], v[96:99]
    buffer_load_dwordx4 a[208:211], v70, s[52:55], s19 offen offset:0 sc1
    v_mfma_f32_16x16x32_bf16 v[104:107], a[28:31], a[136:139], v[104:107]
    v_cndmask_b32 v233, 0, v224, s[88:89]
    v_mfma_f32_16x16x32_bf16 v[112:115], a[24:27], a[132:135], v[112:115]
    ds_read_b64_tr_b16 a[76:77], v54 offset:32776
    v_mfma_f32_16x16x32_bf16 v[120:123], a[24:27], a[140:143], v[120:123]
    ds_read_b64_tr_b16 a[78:79], v54 offset:34824
    v_mfma_f32_16x16x32_bf16 v[128:131], a[28:31], a[132:135], v[128:131]
    buffer_load_dwordx4 a[212:215], v71, s[52:55], s19 offen offset:0 sc1
    v_mfma_f32_16x16x32_bf16 v[136:139], a[28:31], a[140:143], v[136:139]
    v_cmp_eq_u32 s[88:89], 2, v225
    s_nop 0
    s_waitcnt vmcnt(14) lgkmcnt(15)
    v_mfma_f32_16x16x32_bf16 v[92:95], a[36:39], a[144:147], v[92:95]
    ds_read_b64_tr_b16 a[80:81], v52 offset:0
    v_mfma_f32_16x16x32_bf16 v[100:103], a[36:39], a[152:155], v[100:103]
    ds_read_b64_tr_b16 a[82:83], v52 offset:2048
    v_cndmask_b32 v234, 0, v224, s[88:89]
    v_mfma_f32_16x16x32_bf16 v[108:111], a[32:35], a[148:151], v[108:111]
L_pad5:
    s_cbranch_execz L_ret
    s_nop 0
    buffer_load_dwordx4 a[216:219], v70, s[52:55], s19 offen offset:1024 sc1
    v_mfma_f32_16x16x32_bf16 v[116:119], a[32:35], a[156:159], v[116:119]
    v_cmp_eq_u32 s[88:89], 3, v225
    v_mfma_f32_16x16x32_bf16 v[124:127], a[36:39], a[148:151], v[124:127]
    ds_read_b64_tr_b16 a[84:85], v54 offset:0
    v_mfma_f32_16x16x32_bf16 v[132:135], a[36:39], a[156:159], v[132:135]
    ds_read_b64_tr_b16 a[86:87], v54 offset:2048
    v_mfma_f32_16x16x32_bf16 v[96:99], a[44:47], a[144:147], v[96:99]
    buffer_load_dwordx4 a[220:223], v71, s[52:55], s19 offen offset:1024 sc1
    v_mfma_f32_16x16x32_bf16 v[104:107], a[44:47], a[152:155], v[104:107]
    v_cndmask_b32 v235, 0, v224, s[88:89]
    v_mfma_f32_16x16x32_bf16 v[112:115], a[40:43], a[148:151], v[112:115]
    ds_read_b64_tr_b16 a[88:89], v52 offset:8
    v_mfma_f32_16x16x32_bf16 v[120:123], a[40:43], a[156:159], v[120:123]
    ds_read_b64_tr_b16 a[90:91], v52 offset:2056
    v_cmp_eq_u32 s[88:89], -8, v225
    v_mfma_f32_16x16x32_bf16 v[128:131], a[44:47], a[148:151], v[128:131]
    s_nop 0
    v_cndmask_b32 v236, 0, v240, s[88:89]
    v_mfma_f32_16x16x32_bf16 v[136:139], a[44:47], a[156:159], v[136:139]
    s_waitcnt vmcnt(12) lgkmcnt(14)
    v_mfma_f32_16x16x32_bf16 v[92:95], a[52:55], a[160:163], v[92:95]
    ds_read_b64_tr_b16 a[92:93], v54 offset:8
    v_mfma_f32_16x16x32_bf16 v[100:103], a[52:55], a[168:171], v[100:103]
    ds_read_b64_tr_b16 a[94:95], v54 offset:2056
    v_mfma_f32_16x16x32_bf16 v[108:111], a[48:51], a[164:167], v[108:111]
    v_cmp_eq_u32 s[88:89], -7, v225
    v_mfma_f32_16x16x32_bf16 v[116:119], a[48:51], a[172:175], v[116:119]
    s_nop 0
    v_cndmask_b32 v237, 0, v240, s[88:89]
    v_mfma_f32_16x16x32_bf16 v[124:127], a[52:55], a[164:167], v[124:127]
    ds_read_b64_tr_b16 a[96:97], v53 offset:32768
    v_mfma_f32_16x16x32_bf16 v[132:135], a[52:55], a[172:175], v[132:135]
    ds_read_b64_tr_b16 a[98:99], v53 offset:34816
    v_mfma_f32_16x16x32_bf16 v[96:99], a[60:63], a[160:163], v[96:99]
    v_cmp_eq_u32 s[88:89], -6, v225
    v_mfma_f32_16x16x32_bf16 v[104:107], a[60:63], a[168:171], v[104:107]
    s_nop 0
    v_cndmask_b32 v238, 0, v240, s[88:89]
    v_mfma_f32_16x16x32_bf16 v[112:115], a[56:59], a[164:167], v[112:115]
    ds_read_b64_tr_b16 a[100:101], v55 offset:32768
    v_mfma_f32_16x16x32_bf16 v[120:123], a[56:59], a[172:175], v[120:123]
    ds_read_b64_tr_b16 a[102:103], v55 offset:34816
    v_cmp_eq_u32 s[88:89], -5, v225
    v_mfma_f32_16x16x32_bf16 v[128:131], a[60:63], a[164:167], v[128:131]
    s_nop 0
    v_cndmask_b32 v239, 0, v240, s[88:89]
    v_mfma_f32_16x16x32_bf16 v[136:139], a[60:63], a[172:175], v[136:139]
    s_waitcnt vmcnt(8) lgkmcnt(12)
    v_mfma_f32_16x16x32_bf16 v[92:95], a[68:71], a[176:179], v[92:95]
    ds_read_b64_tr_b16 a[104:105], v53 offset:32776
    v_mfma_f32_16x16x32_bf16 v[100:103], a[68:71], a[184:187], v[100:103]
    ds_read_b64_tr_b16 a[106:107], v53 offset:34824
    v_mfma_f32_16x16x32_bf16 v[108:111], a[64:67], a[180:183], v[108:111]
    v_mfma_f32_16x16x32_bf16 v[116:119], a[64:67], a[188:191], v[116:119]
    v_mfma_f32_16x16x32_bf16 v[124:127], a[68:71], a[180:183], v[124:127]
    ds_read_b64_tr_b16 a[108:109], v55 offset:32776
    v_mfma_f32_16x16x32_bf16 v[132:135], a[68:71], a[188:191], v[132:135]
    ds_read_b64_tr_b16 a[110:111], v55 offset:34824
    v_mfma_f32_16x16x32_bf16 v[96:99], a[76:79], a[176:179], v[96:99]
    v_mfma_f32_16x16x32_bf16 v[104:107], a[76:79], a[184:187], v[104:107]
    buffer_load_dwordx4 v[204:207], v220, s[52:55], 0 offen sc1
    v_mfma_f32_16x16x32_bf16 v[112:115], a[72:75], a[180:183], v[112:115]
    v_mfma_f32_16x16x32_bf16 v[120:123], a[72:75], a[188:191], v[120:123]
    v_mfma_f32_16x16x32_bf16 v[128:131], a[76:79], a[180:183], v[128:131]
    buffer_load_dwordx4 v[208:211], v221, s[52:55], 0 offen sc1
    v_mfma_f32_16x16x32_bf16 v[136:139], a[76:79], a[188:191], v[136:139]
    s_waitcnt vmcnt(6) lgkmcnt(8)
    v_mfma_f32_16x16x32_bf16 v[92:95], a[84:87], a[192:195], v[92:95]
    v_mfma_f32_16x16x32_bf16 v[100:103], a[84:87], a[200:203], v[100:103]
    v_mfma_f32_16x16x32_bf16 v[96:99], a[92:95], a[192:195], v[96:99]
    v_mfma_f32_16x16x32_bf16 v[104:107], a[92:95], a[200:203], v[104:107]
    s_waitcnt vmcnt(2) lgkmcnt(0)
    v_mfma_f32_16x16x32_bf16 v[92:95], a[100:103], a[208:211], v[92:95]
    v_mfma_f32_16x16x32_bf16 v[100:103], a[100:103], a[216:219], v[100:103]
    v_mfma_f32_16x16x32_bf16 v[96:99], a[108:111], a[208:211], v[96:99]
    v_mfma_f32_16x16x32_bf16 v[104:107], a[108:111], a[216:219], v[104:107]
    v_mfma_f32_16x16x32_bf16 v[108:111], a[80:83], a[196:199], v[108:111]
    v_mfma_f32_16x16x32_bf16 v[116:119], a[80:83], a[204:207], v[116:119]
    s_nop 0
    s_nop 2
    ds_write_b128 v229, v[92:95] offset:0
    v_mfma_f32_16x16x32_bf16 v[112:115], a[88:91], a[196:199], v[112:115]
    v_mfma_f32_16x16x32_bf16 v[120:123], a[88:91], a[204:207], v[120:123]
    ds_write_b128 v229, v[96:99] offset:1024
    v_mfma_f32_16x16x32_bf16 v[108:111], a[96:99], a[212:215], v[108:111]
    v_mfma_f32_16x16x32_bf16 v[116:119], a[96:99], a[220:223], v[116:119]
    ds_write_b128 v229, v[100:103] offset:2048
    v_mfma_f32_16x16x32_bf16 v[112:115], a[104:107], a[212:215], v[112:115]
    v_mfma_f32_16x16x32_bf16 v[120:123], a[104:107], a[220:223], v[120:123]
    ds_write_b128 v229, v[104:107] offset:3072
    v_mfma_f32_16x16x32_bf16 v[124:127], a[84:87], a[196:199], v[124:127]
    v_mfma_f32_16x16x32_bf16 v[132:135], a[84:87], a[204:207], v[132:135]
    v_mfma_f32_16x16x32_bf16 v[128:131], a[92:95], a[196:199], v[128:131]
    v_mfma_f32_16x16x32_bf16 v[136:139], a[92:95], a[204:207], v[136:139]
    ds_write_b128 v230, v[108:111] offset:0
    v_mfma_f32_16x16x32_bf16 v[124:127], a[100:103], a[212:215], v[124:127]
    v_mfma_f32_16x16x32_bf16 v[132:135], a[100:103], a[220:223], v[132:135]
    ds_write_b128 v230, v[112:115] offset:1024
    v_mfma_f32_16x16x32_bf16 v[128:131], a[108:111], a[212:215], v[128:131]
    v_mfma_f32_16x16x32_bf16 v[136:139], a[108:111], a[220:223], v[136:139]
    ds_write_b128 v230, v[116:119] offset:2048
    v_mfma_f32_16x16x32_bf16 v[76:79], a[32:35], a[144:147], v[76:79]
    v_mfma_f32_16x16x32_bf16 v[84:87], a[32:35], a[152:155], v[84:87]
    v_mfma_f32_16x16x32_bf16 v[80:83], a[40:43], a[144:147], v[80:83]
    v_mfma_f32_16x16x32_bf16 v[88:91], a[40:43], a[152:155], v[88:91]
    ds_write_b128 v230, v[120:123] offset:3072
    v_mfma_f32_16x16x32_bf16 v[76:79], a[48:51], a[160:163], v[76:79]
    v_mfma_f32_16x16x32_bf16 v[84:87], a[48:51], a[168:171], v[84:87]
    ds_write_b128 v231, v[124:127] offset:0
    v_mfma_f32_16x16x32_bf16 v[80:83], a[56:59], a[160:163], v[80:83]
    v_mfma_f32_16x16x32_bf16 v[88:91], a[56:59], a[168:171], v[88:91]
    ds_write_b128 v231, v[128:131] offset:1024
    v_mfma_f32_16x16x32_bf16 v[76:79], a[64:67], a[176:179], v[76:79]
    v_mfma_f32_16x16x32_bf16 v[84:87], a[64:67], a[184:187], v[84:87]
    v_mfma_f32_16x16x32_bf16 v[80:83], a[72:75], a[176:179], v[80:83]
    v_mfma_f32_16x16x32_bf16 v[88:91], a[72:75], a[184:187], v[88:91]
    ds_write_b128 v231, v[132:135] offset:2048
    v_mfma_f32_16x16x32_bf16 v[76:79], a[80:83], a[192:195], v[76:79]
    v_mfma_f32_16x16x32_bf16 v[84:87], a[80:83], a[200:203], v[84:87]
    ds_write_b128 v231, v[136:139] offset:3072
    v_mfma_f32_16x16x32_bf16 v[80:83], a[88:91], a[192:195], v[80:83]
    v_mfma_f32_16x16x32_bf16 v[88:91], a[88:91], a[200:203], v[88:91]
    s_waitcnt lgkmcnt(0)
    s_barrier
    ds_read_b128 v[92:95], v226 offset:0
    ds_read_b128 v[108:111], v227 offset:0
    v_mfma_f32_16x16x32_bf16 v[76:79], a[96:99], a[208:211], v[76:79]
    ds_read_b128 v[124:127], v228 offset:0
    ds_read_b128 v[96:99], v226 offset:1024
    ds_read_b128 v[112:115], v227 offset:1024
    v_mfma_f32_16x16x32_bf16 v[84:87], a[96:99], a[216:219], v[84:87]
    ds_read_b128 v[128:131], v228 offset:1024
    ds_read_b128 v[100:103], v226 offset:2048
    ds_read_b128 v[116:119], v227 offset:2048
    v_mfma_f32_16x16x32_bf16 v[80:83], a[104:107], a[208:211], v[80:83]
    ds_read_b128 v[132:135], v228 offset:2048
    ds_read_b128 v[104:107], v226 offset:3072
    ds_read_b128 v[120:123], v227 offset:3072
    v_mfma_f32_16x16x32_bf16 v[88:91], a[104:107], a[216:219], v[88:91]
    ds_read_b128 v[136:139], v228 offset:3072
    s_waitcnt vmcnt(1)
    v_max3_u32 v3, v204, v205, v206
    s_waitcnt vmcnt(0)
    v_max3_u32 v3, v3, v207, v208
    v_max3_u32 v3, v3, v209, v210
    v_max_u32 v3, v3, v211
    v_cmp_eq_u32 vcc, -1, v3
    s_nop 0
    s_cbranch_vccnz L_slow_13
L_ok_14:
    v_mfma_f32_16x16x32_bf16 v[188:191], v[204:207], v[232:235], 0
    v_mfma_f32_16x16x32_bf16 v[192:195], v[208:211], v[232:235], 0
    s_mov_b64 vcc, s[84:85]
    v_mfma_f32_16x16x32_bf16 v[196:199], v[204:207], v[236:239], 0
    s_waitcnt lgkmcnt(6)
    v_mfma_f32_16x16x32_bf16 v[200:203], v[208:211], v[236:239], 0
    v_pk_add_f32 v[76:77], v[76:77], v[92:93]
    v_pk_add_f32 v[78:79], v[78:79], v[94:95]
    v_pk_add_f32 v[76:77], v[76:77], v[108:109]
    v_pk_add_f32 v[78:79], v[78:79], v[110:111]
    v_pk_add_f32 v[76:77], v[76:77], v[124:125]
    v_pk_add_f32 v[78:79], v[78:79], v[126:127]
    v_pk_fma_f32 v[76:77], v[76:77], v[4:5], v[188:189] op_sel:[0,1,0] op_sel_hi:[1,1,1]
    v_pk_fma_f32 v[78:79], v[78:79], v[4:5], v[190:191] op_sel:[0,1,0] op_sel_hi:[1,1,1]
    v_cvt_pk_bf16_f32 v212, v76, v77
    v_cvt_pk_bf16_f32 v213, v78, v79
    v_pk_add_f32 v[80:81], v[80:81], v[96:97]
    v_pk_add_f32 v[82:83], v[82:83], v[98:99]
    v_pk_add_f32 v[80:81], v[80:81], v[112:113]
    v_pk_add_f32 v[82:83], v[82:83], v[114:115]
    v_pk_add_f32 v[80:81], v[80:81], v[128:129]
    v_pk_add_f32 v[82:83], v[82:83], v[130:131]
    v_pk_fma_f32 v[80:81], v[80:81], v[4:5], v[192:193] op_sel:[0,1,0] op_sel_hi:[1,1,1]
    v_pk_fma_f32 v[82:83], v[82:83], v[4:5], v[194:195] op_sel:[0,1,0] op_sel_hi:[1,1,1]
    v_cvt_pk_bf16_f32 v214, v80, v81
    v_cvt_pk_bf16_f32 v215, v82, v83
    s_nop 0
    s_waitcnt lgkmcnt(0)
    v_pk_add_f32 v[84:85], v[84:85], v[100:101]
    v_pk_add_f32 v[86:87], v[86:87], v[102:103]
    v_pk_add_f32 v[84:85], v[84:85], v[116:117]
    v_pk_add_f32 v[86:87], v[86:87], v[118:119]
    v_pk_add_f32 v[84:85], v[84:85], v[132:133]
    v_pk_add_f32 v[86:87], v[86:87], v[134:135]
    v_pk_fma_f32 v[84:85], v[84:85], v[6:7], v[196:197] op_sel:[0,1,0] op_sel_hi:[1,1,1]
    v_pk_fma_f32 v[86:87], v[86:87], v[6:7], v[198:199] op_sel:[0,1,0] op_sel_hi:[1,1,1]
    v_cvt_pk_bf16_f32 v216, v84, v85
    v_cvt_pk_bf16_f32 v217, v86, v87
    v_pk_add_f32 v[88:89], v[88:89], v[104:105]
    v_pk_add_f32 v[90:91], v[90:91], v[106:107]
    v_pk_add_f32 v[88:89], v[88:89], v[120:121]
    v_pk_add_f32 v[90:91], v[90:91], v[122:123]
    v_pk_add_f32 v[88:89], v[88:89], v[136:137]
    v_pk_add_f32 v[90:91], v[90:91], v[138:139]
    v_pk_fma_f32 v[88:89], v[88:89], v[6:7], v[200:201] op_sel:[0,1,0] op_sel_hi:[1,1,1]
    v_pk_fma_f32 v[90:91], v[90:91], v[6:7], v[202:203] op_sel:[0,1,0] op_sel_hi:[1,1,1]
    v_cvt_pk_bf16_f32 v218, v88, v89
    v_cvt_pk_bf16_f32 v219, v90, v91
    v_permlane16_swap_b32 v212, v216
    v_permlane16_swap_b32 v213, v217
    v_permlane16_swap_b32 v214, v218
    v_permlane16_swap_b32 v215, v219
    v_cndmask_b32_dpp v92, v216, v212, vcc quad_perm:[1,0,3,2] row_mask:0xf bank_mask:0xf
    v_cndmask_b32_dpp v93, v217, v213, vcc quad_perm:[1,0,3,2] row_mask:0xf bank_mask:0xf
    v_cndmask_b32_dpp v94, v218, v214, vcc quad_perm:[1,0,3,2] row_mask:0xf bank_mask:0xf
    v_cndmask_b32_dpp v95, v219, v215, vcc quad_perm:[1,0,3,2] row_mask:0xf bank_mask:0xf
    s_not_b64 vcc, vcc
    v_cndmask_b32_dpp v216, v212, v216, vcc quad_perm:[1,0,3,2] row_mask:0xf bank_mask:0xf
    v_cndmask_b32_dpp v217, v213, v217, vcc quad_perm:[1,0,3,2] row_mask:0xf bank_mask:0xf
    v_cndmask_b32_dpp v218, v214, v218, vcc quad_perm:[1,0,3,2] row_mask:0xf bank_mask:0xf
    v_cndmask_b32_dpp v219, v215, v219, vcc quad_perm:[1,0,3,2] row_mask:0xf bank_mask:0xf
    s_mov_b64 vcc, s[86:87]
    v_permlane32_swap_b32 v92, v216
    v_permlane32_swap_b32 v93, v217
    v_permlane32_swap_b32 v94, v218
    v_permlane32_swap_b32 v95, v219
    v_cndmask_b32_dpp v212, v216, v92, vcc quad_perm:[2,3,0,1] row_mask:0xf bank_mask:0xf
    v_cndmask_b32_dpp v213, v217, v93, vcc quad_perm:[2,3,0,1] row_mask:0xf bank_mask:0xf
    v_cndmask_b32_dpp v214, v218, v94, vcc quad_perm:[2,3,0,1] row_mask:0xf bank_mask:0xf
    v_cndmask_b32_dpp v215, v219, v95, vcc quad_perm:[2,3,0,1] row_mask:0xf bank_mask:0xf
    s_not_b64 vcc, vcc
    buffer_store_dwordx4 v[212:215], v222, s[56:59], 0 offen offset:0
    v_cndmask_b32_dpp v216, v92, v216, vcc quad_perm:[2,3,0,1] row_mask:0xf bank_mask:0xf
    v_cndmask_b32_dpp v217, v93, v217, vcc quad_perm:[2,3,0,1] row_mask:0xf bank_mask:0xf
    v_cndmask_b32_dpp v218, v94, v218, vcc quad_perm:[2,3,0,1] row_mask:0xf bank_mask:0xf
    v_cndmask_b32_dpp v219, v95, v219, vcc quad_perm:[2,3,0,1] row_mask:0xf bank_mask:0xf
    buffer_store_dwordx4 v[216:219], v222, s[56:59], 0 offen offset:1792
    s_endpgm
L_slow_1:
    s_mov_b32 s3, 0
L_lp_3:
    s_add_u32 s3, s3, 1
    s_cmp_gt_u32 s3, 400000
    s_cbranch_scc1 L_ok_2
    global_load_dword v3, v60, s[34:35] sc1
    s_waitcnt vmcnt(0)
    v_cmp_ne_u32 vcc, -1, v3
    s_nop 0
    s_cbranch_vccnz L_lp_3
    s_branch L_ok_2
L_slow_4:
    s_mov_b32 s3, 0
L_lp_6:
    s_add_u32 s3, s3, 1
    s_cmp_gt_u32 s3, 400000
    s_cbranch_scc1 L_ok_5
    buffer_load_dword v3, v60, s[52:55], 0 offen sc1
    s_waitcnt vmcnt(0)
    v_cmp_ne_u32 vcc, -1, v3
    s_nop 0
    s_cbranch_vccnz L_lp_6
    s_branch L_ok_5
L_slow_7:
    s_mov_b32 s3, 0
L_lp_9:
    s_add_u32 s3, s3, 1
    s_cmp_gt_u32 s3, 400000
    s_cbranch_scc1 L_ok_8
    buffer_load_dword v3, v62, s[52:55], 0 offen sc1
    s_waitcnt vmcnt(0)
    v_cmp_ne_u32 vcc, -1, v3
    s_nop 0
    s_cbranch_vccnz L_lp_9
    s_branch L_ok_8
L_slow_10:
    s_mov_b32 s3, 0
L_lp_12:
    s_add_u32 s3, s3, 1
    s_cmp_gt_u32 s3, 400000
    s_cbranch_scc1 L_ok_11
    buffer_load_dword v3, v63, s[52:55], 0 offen sc1
    s_waitcnt vmcnt(0)
    v_cmp_ne_u32 vcc, -1, v3
    s_nop 0
    s_cbranch_vccnz L_lp_12
    s_branch L_ok_11
L_slow_13:
    s_mov_b32 s3, 0
L_lp_15:
    s_add_u32 s3, s3, 1
    s_cmp_gt_u32 s3, 400000
    s_cbranch_scc1 L_ok_14
    buffer_load_dwordx4 v[204:207], v220, s[52:55], 0 offen sc1
    buffer_load_dwordx4 v[208:211], v221, s[52:55], 0 offen sc1
    s_waitcnt vmcnt(0)
    v_max3_u32 v3, v204, v205, v206
    v_max3_u32 v3, v3, v207, v208
    v_max3_u32 v3, v3, v209, v210
    v_max_u32 v3, v3, v211
    v_cmp_eq_u32 vcc, -1, v3
    s_nop 0
    s_cbranch_vccnz L_lp_15
    s_branch L_ok_14
L_helper:
    s_and_b32 s3, s2, 7
    s_lshr_b32 s95, s2, 3
    s_lshl2_add_u32 s94, s3, s95
    s_lshr_b32 s3, s3, 1
    s_lshl2_add_u32 s3, s3, s95
    s_mul_i32 s3, s3, 100352
    s_and_b32 s95, s2, 1
    s_mul_i32 s95, s95, 896
    s_add_u32 s3, s3, s95
    v_min_u32 v19, 195, v0
    v_mul_u32_u24 v20, 9363, v19
    v_lshrrev_b32_e64 v20, 16, v20
    v_mul_u32_u24 v20, 2688, v20
    v_lshl_add_u32 v20, v19, 7, v20
    v_add_u32 v20, s3, v20
    v_mov_b32 v14, 0
    v_mov_b32 v15, 0
    v_mov_b32 v16, 0
    v_mov_b32 v17, 0
    v_mov_b32 v26, -1
    v_mov_b32 v27, -1
    v_mov_b32 v28, -1
    v_mov_b32_e64 v29, -1
    s_mul_i32 s3, s2, 7168
    s_add_u32 s3, s3, 13631488
    v_lshl_add_u32 v18, v0, 4, s3
    v_add_u32 v31, 4096, v18
    s_lshl_b32 s3, s94, 8
    s_add_u32 s3, s3, 13860864
    v_and_b32 v21, 15, v0
    v_lshl_add_u32 v21, v21, 4, s3
    v_cmp_lt_u32 vcc, 191, v0
    s_nop 1
    v_cndmask_b32 v31, v31, v21, vcc
    v_mov_b32 v10, 0x7fffff00
    v_cmp_gt_u32 vcc, 208, v0
    s_nop 1
    v_cndmask_b32 v31, v10, v31, vcc
    v_lshrrev_b32 v8, 3, v1
    v_and_b32 v9, 7, v1
    v_lshrrev_b32 v11, 4, v1
    s_lshl2_add_u32 s3, s94, s60
    s_mul_i32 s3, s3, 14336
    v_mul_u32_u24 v10, 896, v8
    v_add_u32 v10, s3, v10
    v_xor_b32 v11, v9, v11
    v_lshl_add_u32 v12, v11, 4, v10
    v_xor_b32_e64 v11, 4, v11
    v_lshl_add_u32 v13, v11, 4, v10
    v_add_u32 v13, 6144, v13
    s_lshl_b32 s3, s94, 2
    v_mov_b32 v30, s3
    s_mul_i32 s3, s2, 196
    v_add_u32 v19, s3, v19
    v_lshlrev_b32 v19, 7, v19
    v_add_u32 v32, 802816, v19
    s_waitcnt lgkmcnt(0)
    s_mov_b32 s52, s36
    s_and_b32 s53, s37, 0xffff
    s_mov_b32 s54, 33554432
    s_mov_b32 s55, 0x20000
    buffer_store_dwordx4 v[14:17], v18, s[52:55], 0 offen sc1
    buffer_store_dwordx4 v[14:17], v31, s[52:55], 0 offen sc1
    s_mov_b32 s40, s4
    s_and_b32 s41, s5, 0xffff
    s_mov_b32 s42, 1835008
    s_mov_b32 s43, 0x20000
    v_bfe_u32 v10, v1, 2, 2
    v_lshrrev_b32 v11, 4, v1
    v_lshl_add_u32 v33, v10, 2, v11
    v_lshlrev_b32 v33, 7, v33
    v_lshrrev_b32 v35, 5, v1
    v_lshl_add_u32 v10, v10, 1, v35
    v_bfe_u32 v35, v1, 1, 1
    s_lshl_b32 s3, s60, 1
    v_add_u32 v35, s3, v35
    v_xor_b32_e64 v10, v10, v35
    v_lshl_add_u32 v33, v10, 4, v33
    v_and_b32_e64 v10, 1, v1
    v_lshl_add_u32 v33, v10, 3, v33
    s_mul_i32 s3, s60, 16128
    s_add_u32 s3, s3, 65536
    v_and_b32_e64 v10, 15, v1
    v_mul_u32_u24 v10, 144, v10
    v_lshl_add_u32 v10, v11, 4, v10
    v_add_u32_e64 v35, s3, v10
    v_mul_u32_u24 v10, 144, v8
    v_lshl_add_u32 v10, v9, 4, v10
    v_add_u32 v92, s3, v10
    v_lshlrev_b32 v34, 12, v8
    v_lshl_add_u32 v34, v9, 4, v34
    v_lshlrev_b32 v18, 4, v0
    s_mul_i32 s95, s2, 57344
    s_add_u32 s95, s95, 10485760
    s_add_u32 s3, s95, 0
    buffer_store_dwordx4 v[26:29], v18, s[52:55], s3 offen sc1
    s_add_u32 s3, s95, 4096
    buffer_store_dwordx4 v[26:29], v18, s[52:55], s3 offen sc1
    s_add_u32 s3, s95, 8192
    buffer_store_dwordx4 v[26:29], v18, s[52:55], s3 offen sc1
    s_add_u32 s3, s95, 12288
    buffer_store_dwordx4 v[26:29], v18, s[52:55], s3 offen sc1
    s_add_u32 s3, s95, 16384
    buffer_store_dwordx4 v[26:29], v18, s[52:55], s3 offen sc1
    s_add_u32 s3, s95, 20480
    buffer_store_dwordx4 v[26:29], v18, s[52:55], s3 offen sc1
    s_add_u32 s3, s95, 24576
    buffer_store_dwordx4 v[26:29], v18, s[52:55], s3 offen sc1
    s_add_u32 s3, s95, 28672
    buffer_store_dwordx4 v[26:29], v18, s[52:55], s3 offen sc1
    s_add_u32 s3, s95, 32768
    buffer_store_dwordx4 v[26:29], v18, s[52:55], s3 offen sc1
    s_add_u32 s3, s95, 36864
    buffer_store_dwordx4 v[26:29], v18, s[52:55], s3 offen sc1
    s_add_u32 s3, s95, 40960
    buffer_store_dwordx4 v[26:29], v18, s[52:55], s3 offen sc1
    s_add_u32 s3, s95, 45056
    buffer_store_dwordx4 v[26:29], v18, s[52:55], s3 offen sc1
    s_add_u32 s3, s95, 49152
    buffer_store_dwordx4 v[26:29], v18, s[52:55], s3 offen sc1
    s_add_u32 s3, s95, 53248
    buffer_store_dwordx4 v[26:29], v18, s[52:55], s3 offen sc1
    s_mov_b32 s44, s30
    s_and_b32 s45, s31, 0xffff
    s_mov_b32 s46, 896
    s_mov_b32 s47, 0x20000
    s_lshl_b32 s95, s60, 10
    s_add_u32 m0, s95, 57344
    v_lshlrev_b32 v10, 4, v1
    buffer_load_dwordx4 v10, s[44:47], 0 offen lds
    s_lshl_b32 s95, s60, 11
    s_add_u32 m0, s95, 0
    s_mov_b32 s3, 0
    buffer_load_dwordx4 v12, s[40:43], s3 offen lds
    buffer_load_dwordx4 v13, s[40:43], s3 offen offset:1024 lds
    s_add_u32 m0, s95, 8192
    s_mov_b32 s3, 128
    buffer_load_dwordx4 v12, s[40:43], s3 offen lds
    buffer_load_dwordx4 v13, s[40:43], s3 offen offset:1024 lds
    s_add_u32 m0, s95, 16384
    s_mov_b32 s3, 256
    buffer_load_dwordx4 v12, s[40:43], s3 offen lds
    buffer_load_dwordx4 v13, s[40:43], s3 offen offset:1024 lds
    s_add_u32 m0, s95, 24576
    s_mov_b32 s3, 384
    buffer_load_dwordx4 v12, s[40:43], s3 offen lds
    buffer_load_dwordx4 v13, s[40:43], s3 offen offset:1024 lds
    s_add_u32 m0, s95, 32768
    s_mov_b32 s3, 512
    buffer_load_dwordx4 v12, s[40:43], s3 offen lds
    buffer_load_dwordx4 v13, s[40:43], s3 offen offset:1024 lds
    s_add_u32 m0, s95, 40960
    s_mov_b32 s3, 640
    buffer_load_dwordx4 v12, s[40:43], s3 offen lds
    buffer_load_dwordx4 v13, s[40:43], s3 offen offset:1024 lds
    s_add_u32 m0, s95, 49152
    s_mov_b32 s3, 768
    buffer_load_dwordx4 v12, s[40:43], s3 offen lds
    buffer_load_dwordx4 v13, s[40:43], s3 offen offset:1024 lds
    s_waitcnt vmcnt(15)
    s_barrier
    s_cmp_eq_u32 s60, 0
    s_cbranch_scc0 L_h0
    s_mov_b64 exec, 1
    global_store_dword v30, v26, s[34:35] sc1
    s_mov_b64 exec, -1
L_h0:
    global_load_dword v22, v20, s[24:25] offset:1792
    global_load_dword v23, v20, s[26:27] offset:1792
    s_lshl_b32 s3, s60, 16
    s_lshl_b32 s95, s94, 7
    s_nop 0
    s_add_u32 s95, s95, s3
    s_add_u32 s95, s95, 8388608
    s_waitcnt vmcnt(2)
    s_barrier
    ds_read_b64_tr_b16 v[36:37], v33 offset:0
    ds_read_b64_tr_b16 v[38:39], v33 offset:2048
    ds_read_b64_tr_b16 v[40:41], v33 offset:4096
    ds_read_b64_tr_b16 v[42:43], v33 offset:6144
    ds_read_b64_tr_b16 v[44:45], v33 offset:8192
    ds_read_b64_tr_b16 v[46:47], v33 offset:10240
    ds_read_b64_tr_b16 v[48:49], v33 offset:12288
    ds_read_b64_tr_b16 v[50:51], v33 offset:14336
    ds_read_b64_tr_b16 v[52:53], v33 offset:16384
    ds_read_b64_tr_b16 v[54:55], v33 offset:18432
    ds_read_b64_tr_b16 v[56:57], v33 offset:20480
    ds_read_b64_tr_b16 v[58:59], v33 offset:22528
    ds_read_b64_tr_b16 v[60:61], v33 offset:24576
    ds_read_b64_tr_b16 v[62:63], v33 offset:26624
    ds_read_b64_tr_b16 v[64:65], v33 offset:28672
    ds_read_b64_tr_b16 v[66:67], v33 offset:30720
    ds_read_b64_tr_b16 v[68:69], v33 offset:32768
    ds_read_b64_tr_b16 v[70:71], v33 offset:34816
    ds_read_b64_tr_b16 v[72:73], v33 offset:36864
    ds_read_b64_tr_b16 v[74:75], v33 offset:38912
    ds_read_b64_tr_b16 v[76:77], v33 offset:40960
    ds_read_b64_tr_b16 v[78:79], v33 offset:43008
    ds_read_b64_tr_b16 v[80:81], v33 offset:45056
    ds_read_b64_tr_b16 v[82:83], v33 offset:47104
    ds_read_b64_tr_b16 v[84:85], v33 offset:49152
    ds_read_b64_tr_b16 v[86:87], v33 offset:51200
    ds_read_b64_tr_b16 v[88:89], v33 offset:53248
    ds_read_b64_tr_b16 v[90:91], v33 offset:55296
    s_waitcnt lgkmcnt(15)
    ds_write_b128 v35, v[36:39] offset:0
    ds_write_b128 v35, v[40:43] offset:64
    ds_read_b128 v[36:39], v92 offset:0
    ds_read_b128 v[40:43], v92 offset:1152
    ds_write_b128 v35, v[44:47] offset:2304
    ds_write_b128 v35, v[48:51] offset:2368
    ds_read_b128 v[44:47], v92 offset:2304
    ds_read_b128 v[48:51], v92 offset:3456
    s_add_u32 s3, s95, 0
    s_waitcnt lgkmcnt(5)
    buffer_store_dwordx4 v[36:39], v34, s[52:55], s3 offen sc1
    s_add_u32 s3, s95, 32768
    s_waitcnt lgkmcnt(4)
    buffer_store_dwordx4 v[40:43], v34, s[52:55], s3 offen sc1
    ds_write_b128 v35, v[52:55] offset:4608
    ds_write_b128 v35, v[56:59] offset:4672
    ds_read_b128 v[52:55], v92 offset:4608
    ds_read_b128 v[56:59], v92 offset:5760
    s_add_u32 s3, s95, 262144
    s_waitcnt lgkmcnt(5)
    buffer_store_dwordx4 v[44:47], v34, s[52:55], s3 offen sc1
    s_add_u32 s3, s95, 294912
    s_waitcnt lgkmcnt(4)
    buffer_store_dwordx4 v[48:51], v34, s[52:55], s3 offen sc1
    ds_write_b128 v35, v[60:63] offset:6912
    ds_write_b128 v35, v[64:67] offset:6976
    ds_read_b128 v[60:63], v92 offset:6912
    ds_read_b128 v[64:67], v92 offset:8064
    s_add_u32 s3, s95, 524288
    s_waitcnt lgkmcnt(5)
    buffer_store_dwordx4 v[52:55], v34, s[52:55], s3 offen sc1
    s_add_u32 s3, s95, 557056
    s_waitcnt lgkmcnt(4)
    buffer_store_dwordx4 v[56:59], v34, s[52:55], s3 offen sc1
    ds_write_b128 v35, v[68:71] offset:9216
    ds_write_b128 v35, v[72:75] offset:9280
    ds_read_b128 v[68:71], v92 offset:9216
    ds_read_b128 v[72:75], v92 offset:10368
    s_add_u32 s3, s95, 786432
    s_waitcnt lgkmcnt(5)
    buffer_store_dwordx4 v[60:63], v34, s[52:55], s3 offen sc1
    s_add_u32 s3, s95, 819200
    s_waitcnt lgkmcnt(4)
    buffer_store_dwordx4 v[64:67], v34, s[52:55], s3 offen sc1
    ds_write_b128 v35, v[76:79] offset:11520
    ds_write_b128 v35, v[80:83] offset:11584
    ds_read_b128 v[76:79], v92 offset:11520
    ds_read_b128 v[80:83], v92 offset:12672
    s_add_u32 s3, s95, 1048576
    s_waitcnt lgkmcnt(5)
    buffer_store_dwordx4 v[68:71], v34, s[52:55], s3 offen sc1
    s_add_u32 s3, s95, 1081344
    s_waitcnt lgkmcnt(4)
    buffer_store_dwordx4 v[72:75], v34, s[52:55], s3 offen sc1
    ds_write_b128 v35, v[84:87] offset:13824
    ds_write_b128 v35, v[88:91] offset:13888
    ds_read_b128 v[84:87], v92 offset:13824
    ds_read_b128 v[88:91], v92 offset:14976
    s_add_u32 s3, s95, 1310720
    s_waitcnt lgkmcnt(5)
    buffer_store_dwordx4 v[76:79], v34, s[52:55], s3 offen sc1
    s_add_u32 s3, s95, 1343488
    s_waitcnt lgkmcnt(4)
    buffer_store_dwordx4 v[80:83], v34, s[52:55], s3 offen sc1
    s_add_u32 s3, s95, 1572864
    s_waitcnt lgkmcnt(1)
    buffer_store_dwordx4 v[84:87], v34, s[52:55], s3 offen sc1
    s_add_u32 s3, s95, 1605632
    s_waitcnt lgkmcnt(0)
    buffer_store_dwordx4 v[88:91], v34, s[52:55], s3 offen sc1
    v_and_b32 v93, 3, v0
    v_lshlrev_b32 v11, 1, v93
    v_lshlrev_b32 v93, 5, v93
    v_lshrrev_b32 v10, 2, v0
    v_bfe_u32 v206, v0, 3, 3
    v_xor_b32 v11, v11, v206
    v_lshlrev_b32 v10, 7, v10
    v_lshl_add_u32 v206, v11, 4, v10
    v_xor_b32_e64 v207, 16, v206
    ds_read_b128 v[150:153], v206 offset:0
    ds_read_b128 v[154:157], v207 offset:0
    ds_read_b128 v[158:161], v206 offset:8192
    ds_read_b128 v[162:165], v207 offset:8192
    ds_read_b128 v[166:169], v206 offset:16384
    ds_read_b128 v[170:173], v207 offset:16384
    ds_read_b128 v[174:177], v206 offset:24576
    ds_read_b128 v[178:181], v207 offset:24576
    ds_read_b128 v[182:185], v206 offset:32768
    ds_read_b128 v[186:189], v207 offset:32768
    ds_read_b128 v[190:193], v206 offset:40960
    ds_read_b128 v[194:197], v207 offset:40960
    ds_read_b128 v[198:201], v206 offset:49152
    ds_read_b128 v[202:205], v207 offset:49152
    s_waitcnt vmcnt(0)
    s_barrier
    s_cmp_eq_u32 s60, 0
    s_cbranch_scc0 L_h1
    s_mov_b64 exec, 0xff00
    buffer_store_dwordx4 v[26:29], v21, s[52:55], 0 offen sc1
    s_nop 0
    s_mov_b64 exec, -1
L_h1:
    global_load_dword v24, v19, s[28:29]
    global_load_dword v25, v32, s[28:29]
    ds_read_b128 v[94:97], v93 offset:57344
    ds_read_b128 v[98:101], v93 offset:57360
    ds_read_b128 v[102:105], v93 offset:57472
    ds_read_b128 v[106:109], v93 offset:57488
    ds_read_b128 v[110:113], v93 offset:57600
    ds_read_b128 v[114:117], v93 offset:57616
    ds_read_b128 v[118:121], v93 offset:57728
    ds_read_b128 v[122:125], v93 offset:57744
    ds_read_b128 v[126:129], v93 offset:57856
    ds_read_b128 v[130:133], v93 offset:57872
    ds_read_b128 v[134:137], v93 offset:57984
    ds_read_b128 v[138:141], v93 offset:58000
    ds_read_b128 v[142:145], v93 offset:58112
    ds_read_b128 v[146:149], v93 offset:58128
    v_mov_b32 v208, 0
    v_mov_b32 v209, 0
    s_waitcnt lgkmcnt(15)
    v_lshlrev_b32 v210, 16, v150
    v_and_b32 v211, 0xffff0000, v150
    s_waitcnt lgkmcnt(13)
    v_lshlrev_b32 v212, 16, v94
    v_and_b32 v213, 0xffff0000, v94
    v_lshlrev_b32_e64 v214, 16, v151
    v_and_b32 v215, 0xffff0000, v151
    v_lshlrev_b32_e64 v216, 16, v95
    v_and_b32 v217, 0xffff0000, v95
    v_pk_mul_f32 v[210:211], v[210:211], v[212:213]
    v_pk_mul_f32 v[214:215], v[214:215], v[216:217]
    v_cvt_pk_bf16_f32 v212, v210, v211
    v_cvt_pk_bf16_f32 v216, v214, v215
    v_lshlrev_b32_e64 v210, 16, v212
    v_and_b32 v211, 0xffff0000, v212
    v_lshlrev_b32_e64 v214, 16, v216
    v_and_b32 v215, 0xffff0000, v216
    v_pk_add_f32 v[208:209], v[208:209], v[210:211]
    v_pk_add_f32 v[208:209], v[208:209], v[214:215]
    v_lshlrev_b32_e64 v210, 16, v152
    v_and_b32 v211, 0xffff0000, v152
    v_lshlrev_b32_e64 v212, 16, v96
    v_and_b32 v213, 0xffff0000, v96
    v_lshlrev_b32_e64 v214, 16, v153
    v_and_b32 v215, 0xffff0000, v153
    v_lshlrev_b32_e64 v216, 16, v97
    v_and_b32 v217, 0xffff0000, v97
    v_pk_mul_f32 v[210:211], v[210:211], v[212:213]
    v_pk_mul_f32 v[214:215], v[214:215], v[216:217]
    v_cvt_pk_bf16_f32 v212, v210, v211
    v_cvt_pk_bf16_f32 v216, v214, v215
    v_lshlrev_b32_e64 v210, 16, v212
    v_and_b32 v211, 0xffff0000, v212
    v_lshlrev_b32_e64 v214, 16, v216
    v_and_b32 v215, 0xffff0000, v216
    v_pk_add_f32 v[208:209], v[208:209], v[210:211]
    v_pk_add_f32 v[208:209], v[208:209], v[214:215]
    v_lshlrev_b32_e64 v210, 16, v154
    v_and_b32 v211, 0xffff0000, v154
    s_waitcnt lgkmcnt(12)
    v_lshlrev_b32 v212, 16, v98
    v_and_b32 v213, 0xffff0000, v98
    v_lshlrev_b32_e64 v214, 16, v155
    v_and_b32 v215, 0xffff0000, v155
    v_lshlrev_b32_e64 v216, 16, v99
    v_and_b32 v217, 0xffff0000, v99
    v_pk_mul_f32 v[210:211], v[210:211], v[212:213]
    v_pk_mul_f32 v[214:215], v[214:215], v[216:217]
    v_cvt_pk_bf16_f32 v212, v210, v211
    v_cvt_pk_bf16_f32 v216, v214, v215
    v_lshlrev_b32_e64 v210, 16, v212
    v_and_b32 v211, 0xffff0000, v212
    v_lshlrev_b32_e64 v214, 16, v216
    v_and_b32 v215, 0xffff0000, v216
    v_pk_add_f32 v[208:209], v[208:209], v[210:211]
    v_pk_add_f32 v[208:209], v[208:209], v[214:215]
    v_lshlrev_b32_e64 v210, 16, v156
    v_and_b32 v211, 0xffff0000, v156
    v_lshlrev_b32_e64 v212, 16, v100
    v_and_b32 v213, 0xffff0000, v100
    v_lshlrev_b32_e64 v214, 16, v157
    v_and_b32 v215, 0xffff0000, v157
    v_lshlrev_b32_e64 v216, 16, v101
    v_and_b32 v217, 0xffff0000, v101
    v_pk_mul_f32 v[210:211], v[210:211], v[212:213]
    v_pk_mul_f32 v[214:215], v[214:215], v[216:217]
    v_cvt_pk_bf16_f32 v212, v210, v211
    v_cvt_pk_bf16_f32 v216, v214, v215
    v_lshlrev_b32_e64 v210, 16, v212
    v_and_b32 v211, 0xffff0000, v212
    v_lshlrev_b32_e64 v214, 16, v216
    v_and_b32 v215, 0xffff0000, v216
    v_pk_add_f32 v[208:209], v[208:209], v[210:211]
    v_pk_add_f32 v[208:209], v[208:209], v[214:215]
    v_lshlrev_b32_e64 v210, 16, v158
    v_and_b32 v211, 0xffff0000, v158
    s_waitcnt lgkmcnt(11)
    v_lshlrev_b32 v212, 16, v102
    v_and_b32 v213, 0xffff0000, v102
    v_lshlrev_b32_e64 v214, 16, v159
    v_and_b32 v215, 0xffff0000, v159
    v_lshlrev_b32_e64 v216, 16, v103
    v_and_b32 v217, 0xffff0000, v103
    v_pk_mul_f32 v[210:211], v[210:211], v[212:213]
    v_pk_mul_f32 v[214:215], v[214:215], v[216:217]
    v_cvt_pk_bf16_f32 v212, v210, v211
    v_cvt_pk_bf16_f32 v216, v214, v215
    v_lshlrev_b32_e64 v210, 16, v212
    v_and_b32 v211, 0xffff0000, v212
    v_lshlrev_b32_e64 v214, 16, v216
    v_and_b32 v215, 0xffff0000, v216
    v_pk_add_f32 v[208:209], v[208:209], v[210:211]
    v_pk_add_f32 v[208:209], v[208:209], v[214:215]
    v_lshlrev_b32_e64 v210, 16, v160
    v_and_b32 v211, 0xffff0000, v160
    v_lshlrev_b32_e64 v212, 16, v104
    v_and_b32 v213, 0xffff0000, v104
    v_lshlrev_b32_e64 v214, 16, v161
    v_and_b32 v215, 0xffff0000, v161
    v_lshlrev_b32_e64 v216, 16, v105
    v_and_b32 v217, 0xffff0000, v105
    v_pk_mul_f32 v[210:211], v[210:211], v[212:213]
    v_pk_mul_f32 v[214:215], v[214:215], v[216:217]
    v_cvt_pk_bf16_f32 v212, v210, v211
    v_cvt_pk_bf16_f32 v216, v214, v215
    v_lshlrev_b32_e64 v210, 16, v212
    v_and_b32 v211, 0xffff0000, v212
    v_lshlrev_b32_e64 v214, 16, v216
    v_and_b32 v215, 0xffff0000, v216
    v_pk_add_f32 v[208:209], v[208:209], v[210:211]
    v_pk_add_f32 v[208:209], v[208:209], v[214:215]
    v_lshlrev_b32_e64 v210, 16, v162
    v_and_b32 v211, 0xffff0000, v162
    s_waitcnt lgkmcnt(10)
    v_lshlrev_b32 v212, 16, v106
    v_and_b32 v213, 0xffff0000, v106
    v_lshlrev_b32_e64 v214, 16, v163
    v_and_b32 v215, 0xffff0000, v163
    v_lshlrev_b32_e64 v216, 16, v107
    v_and_b32 v217, 0xffff0000, v107
    v_pk_mul_f32 v[210:211], v[210:211], v[212:213]
    v_pk_mul_f32 v[214:215], v[214:215], v[216:217]
    v_cvt_pk_bf16_f32 v212, v210, v211
    v_cvt_pk_bf16_f32 v216, v214, v215
    v_lshlrev_b32_e64 v210, 16, v212
    v_and_b32 v211, 0xffff0000, v212
    v_lshlrev_b32_e64 v214, 16, v216
    v_and_b32 v215, 0xffff0000, v216
    v_pk_add_f32 v[208:209], v[208:209], v[210:211]
    v_pk_add_f32 v[208:209], v[208:209], v[214:215]
    v_lshlrev_b32_e64 v210, 16, v164
    v_and_b32 v211, 0xffff0000, v164
    v_lshlrev_b32_e64 v212, 16, v108
    v_and_b32 v213, 0xffff0000, v108
    v_lshlrev_b32_e64 v214, 16, v165
    v_and_b32 v215, 0xffff0000, v165
    v_lshlrev_b32_e64 v216, 16, v109
    v_and_b32 v217, 0xffff0000, v109
    v_pk_mul_f32 v[210:211], v[210:211], v[212:213]
    v_pk_mul_f32 v[214:215], v[214:215], v[216:217]
    v_cvt_pk_bf16_f32 v212, v210, v211
    v_cvt_pk_bf16_f32 v216, v214, v215
    v_lshlrev_b32_e64 v210, 16, v212
    v_and_b32 v211, 0xffff0000, v212
    v_lshlrev_b32_e64 v214, 16, v216
    v_and_b32 v215, 0xffff0000, v216
    v_pk_add_f32 v[208:209], v[208:209], v[210:211]
    v_pk_add_f32 v[208:209], v[208:209], v[214:215]
    v_lshlrev_b32_e64 v210, 16, v166
    v_and_b32 v211, 0xffff0000, v166
    s_waitcnt lgkmcnt(9)
    v_lshlrev_b32 v212, 16, v110
    v_and_b32 v213, 0xffff0000, v110
    v_lshlrev_b32_e64 v214, 16, v167
    v_and_b32 v215, 0xffff0000, v167
    v_lshlrev_b32_e64 v216, 16, v111
    v_and_b32 v217, 0xffff0000, v111
    v_pk_mul_f32 v[210:211], v[210:211], v[212:213]
    v_pk_mul_f32 v[214:215], v[214:215], v[216:217]
    v_cvt_pk_bf16_f32 v212, v210, v211
    v_cvt_pk_bf16_f32 v216, v214, v215
    v_lshlrev_b32_e64 v210, 16, v212
    v_and_b32 v211, 0xffff0000, v212
    v_lshlrev_b32_e64 v214, 16, v216
    v_and_b32 v215, 0xffff0000, v216
    v_pk_add_f32 v[208:209], v[208:209], v[210:211]
    v_pk_add_f32 v[208:209], v[208:209], v[214:215]
    v_lshlrev_b32_e64 v210, 16, v168
    v_and_b32 v211, 0xffff0000, v168
    v_lshlrev_b32_e64 v212, 16, v112
    v_and_b32 v213, 0xffff0000, v112
    v_lshlrev_b32_e64 v214, 16, v169
    v_and_b32 v215, 0xffff0000, v169
    v_lshlrev_b32_e64 v216, 16, v113
    v_and_b32 v217, 0xffff0000, v113
    v_pk_mul_f32 v[210:211], v[210:211], v[212:213]
    v_pk_mul_f32 v[214:215], v[214:215], v[216:217]
    v_cvt_pk_bf16_f32 v212, v210, v211
    v_cvt_pk_bf16_f32 v216, v214, v215
    v_lshlrev_b32_e64 v210, 16, v212
    v_and_b32 v211, 0xffff0000, v212
    v_lshlrev_b32_e64 v214, 16, v216
    v_and_b32 v215, 0xffff0000, v216
    v_pk_add_f32 v[208:209], v[208:209], v[210:211]
    v_pk_add_f32 v[208:209], v[208:209], v[214:215]
    v_lshlrev_b32_e64 v210, 16, v170
    v_and_b32 v211, 0xffff0000, v170
    s_waitcnt lgkmcnt(8)
    v_lshlrev_b32 v212, 16, v114
    v_and_b32 v213, 0xffff0000, v114
    v_lshlrev_b32_e64 v214, 16, v171
    v_and_b32 v215, 0xffff0000, v171
    v_lshlrev_b32_e64 v216, 16, v115
    v_and_b32 v217, 0xffff0000, v115
    v_pk_mul_f32 v[210:211], v[210:211], v[212:213]
    v_pk_mul_f32 v[214:215], v[214:215], v[216:217]
    v_cvt_pk_bf16_f32 v212, v210, v211
    v_cvt_pk_bf16_f32 v216, v214, v215
    v_lshlrev_b32_e64 v210, 16, v212
    v_and_b32 v211, 0xffff0000, v212
    v_lshlrev_b32_e64 v214, 16, v216
    v_and_b32 v215, 0xffff0000, v216
    v_pk_add_f32 v[208:209], v[208:209], v[210:211]
    v_pk_add_f32 v[208:209], v[208:209], v[214:215]
    v_lshlrev_b32_e64 v210, 16, v172
    v_and_b32 v211, 0xffff0000, v172
    v_lshlrev_b32_e64 v212, 16, v116
    v_and_b32 v213, 0xffff0000, v116
    v_lshlrev_b32_e64 v214, 16, v173
    v_and_b32 v215, 0xffff0000, v173
    v_lshlrev_b32_e64 v216, 16, v117
    v_and_b32 v217, 0xffff0000, v117
    v_pk_mul_f32 v[210:211], v[210:211], v[212:213]
    v_pk_mul_f32 v[214:215], v[214:215], v[216:217]
    v_cvt_pk_bf16_f32 v212, v210, v211
    v_cvt_pk_bf16_f32 v216, v214, v215
    v_lshlrev_b32_e64 v210, 16, v212
    v_and_b32 v211, 0xffff0000, v212
    v_lshlrev_b32_e64 v214, 16, v216
    v_and_b32 v215, 0xffff0000, v216
    v_pk_add_f32 v[208:209], v[208:209], v[210:211]
    v_pk_add_f32 v[208:209], v[208:209], v[214:215]
    v_lshlrev_b32_e64 v210, 16, v174
    v_and_b32 v211, 0xffff0000, v174
    s_waitcnt lgkmcnt(7)
    v_lshlrev_b32 v212, 16, v118
    v_and_b32 v213, 0xffff0000, v118
    v_lshlrev_b32_e64 v214, 16, v175
    v_and_b32 v215, 0xffff0000, v175
    v_lshlrev_b32_e64 v216, 16, v119
    v_and_b32 v217, 0xffff0000, v119
    v_pk_mul_f32 v[210:211], v[210:211], v[212:213]
    v_pk_mul_f32 v[214:215], v[214:215], v[216:217]
    v_cvt_pk_bf16_f32 v212, v210, v211
    v_cvt_pk_bf16_f32 v216, v214, v215
    v_lshlrev_b32_e64 v210, 16, v212
    v_and_b32 v211, 0xffff0000, v212
    v_lshlrev_b32_e64 v214, 16, v216
    v_and_b32 v215, 0xffff0000, v216
    v_pk_add_f32 v[208:209], v[208:209], v[210:211]
    v_pk_add_f32 v[208:209], v[208:209], v[214:215]
    v_lshlrev_b32_e64 v210, 16, v176
    v_and_b32 v211, 0xffff0000, v176
    v_lshlrev_b32_e64 v212, 16, v120
    v_and_b32 v213, 0xffff0000, v120
    v_lshlrev_b32_e64 v214, 16, v177
    v_and_b32 v215, 0xffff0000, v177
    v_lshlrev_b32_e64 v216, 16, v121
    v_and_b32 v217, 0xffff0000, v121
    v_pk_mul_f32 v[210:211], v[210:211], v[212:213]
    v_pk_mul_f32 v[214:215], v[214:215], v[216:217]
    v_cvt_pk_bf16_f32 v212, v210, v211
    v_cvt_pk_bf16_f32 v216, v214, v215
    v_lshlrev_b32_e64 v210, 16, v212
    v_and_b32 v211, 0xffff0000, v212
    v_lshlrev_b32_e64 v214, 16, v216
    v_and_b32 v215, 0xffff0000, v216
    v_pk_add_f32 v[208:209], v[208:209], v[210:211]
    v_pk_add_f32 v[208:209], v[208:209], v[214:215]
    v_lshlrev_b32_e64 v210, 16, v178
    v_and_b32 v211, 0xffff0000, v178
    s_waitcnt lgkmcnt(6)
    v_lshlrev_b32 v212, 16, v122
    v_and_b32 v213, 0xffff0000, v122
    v_lshlrev_b32_e64 v214, 16, v179
    v_and_b32 v215, 0xffff0000, v179
    v_lshlrev_b32_e64 v216, 16, v123
    v_and_b32 v217, 0xffff0000, v123
    v_pk_mul_f32 v[210:211], v[210:211], v[212:213]
    v_pk_mul_f32 v[214:215], v[214:215], v[216:217]
    v_cvt_pk_bf16_f32 v212, v210, v211
    v_cvt_pk_bf16_f32 v216, v214, v215
    v_lshlrev_b32_e64 v210, 16, v212
    v_and_b32 v211, 0xffff0000, v212
    v_lshlrev_b32_e64 v214, 16, v216
    v_and_b32 v215, 0xffff0000, v216
    v_pk_add_f32 v[208:209], v[208:209], v[210:211]
    v_pk_add_f32 v[208:209], v[208:209], v[214:215]
    v_lshlrev_b32_e64 v210, 16, v180
    v_and_b32 v211, 0xffff0000, v180
    v_lshlrev_b32_e64 v212, 16, v124
    v_and_b32 v213, 0xffff0000, v124
    v_lshlrev_b32_e64 v214, 16, v181
    v_and_b32 v215, 0xffff0000, v181
    v_lshlrev_b32_e64 v216, 16, v125
    v_and_b32 v217, 0xffff0000, v125
    v_pk_mul_f32 v[210:211], v[210:211], v[212:213]
    v_pk_mul_f32 v[214:215], v[214:215], v[216:217]
    v_cvt_pk_bf16_f32 v212, v210, v211
    v_cvt_pk_bf16_f32 v216, v214, v215
    v_lshlrev_b32_e64 v210, 16, v212
    v_and_b32 v211, 0xffff0000, v212
    v_lshlrev_b32_e64 v214, 16, v216
    v_and_b32 v215, 0xffff0000, v216
    v_pk_add_f32 v[208:209], v[208:209], v[210:211]
    v_pk_add_f32 v[208:209], v[208:209], v[214:215]
    v_lshlrev_b32_e64 v210, 16, v182
    v_and_b32 v211, 0xffff0000, v182
    s_waitcnt lgkmcnt(5)
    v_lshlrev_b32 v212, 16, v126
    v_and_b32 v213, 0xffff0000, v126
    v_lshlrev_b32_e64 v214, 16, v183
    v_and_b32 v215, 0xffff0000, v183
    v_lshlrev_b32_e64 v216, 16, v127
    v_and_b32 v217, 0xffff0000, v127
    v_pk_mul_f32 v[210:211], v[210:211], v[212:213]
    v_pk_mul_f32 v[214:215], v[214:215], v[216:217]
    v_cvt_pk_bf16_f32 v212, v210, v211
    v_cvt_pk_bf16_f32 v216, v214, v215
    v_lshlrev_b32_e64 v210, 16, v212
    v_and_b32 v211, 0xffff0000, v212
    v_lshlrev_b32_e64 v214, 16, v216
    v_and_b32 v215, 0xffff0000, v216
    v_pk_add_f32 v[208:209], v[208:209], v[210:211]
    v_pk_add_f32 v[208:209], v[208:209], v[214:215]
    v_lshlrev_b32_e64 v210, 16, v184
    v_and_b32 v211, 0xffff0000, v184
    v_lshlrev_b32_e64 v212, 16, v128
    v_and_b32 v213, 0xffff0000, v128
    v_lshlrev_b32_e64 v214, 16, v185
    v_and_b32 v215, 0xffff0000, v185
    v_lshlrev_b32_e64 v216, 16, v129
    v_and_b32 v217, 0xffff0000, v129
    v_pk_mul_f32 v[210:211], v[210:211], v[212:213]
    v_pk_mul_f32 v[214:215], v[214:215], v[216:217]
    v_cvt_pk_bf16_f32 v212, v210, v211
    v_cvt_pk_bf16_f32 v216, v214, v215
    v_lshlrev_b32_e64 v210, 16, v212
    v_and_b32 v211, 0xffff0000, v212
    v_lshlrev_b32_e64 v214, 16, v216
    v_and_b32 v215, 0xffff0000, v216
    v_pk_add_f32 v[208:209], v[208:209], v[210:211]
    v_pk_add_f32 v[208:209], v[208:209], v[214:215]
    v_lshlrev_b32_e64 v210, 16, v186
    v_and_b32 v211, 0xffff0000, v186
    s_waitcnt lgkmcnt(4)
    v_lshlrev_b32 v212, 16, v130
    v_and_b32 v213, 0xffff0000, v130
    v_lshlrev_b32_e64 v214, 16, v187
    v_and_b32 v215, 0xffff0000, v187
    v_lshlrev_b32_e64 v216, 16, v131
    v_and_b32 v217, 0xffff0000, v131
    v_pk_mul_f32 v[210:211], v[210:211], v[212:213]
    v_pk_mul_f32 v[214:215], v[214:215], v[216:217]
    v_cvt_pk_bf16_f32 v212, v210, v211
    v_cvt_pk_bf16_f32 v216, v214, v215
    v_lshlrev_b32_e64 v210, 16, v212
    v_and_b32 v211, 0xffff0000, v212
    v_lshlrev_b32_e64 v214, 16, v216
    v_and_b32 v215, 0xffff0000, v216
    v_pk_add_f32 v[208:209], v[208:209], v[210:211]
    v_pk_add_f32 v[208:209], v[208:209], v[214:215]
    v_lshlrev_b32_e64 v210, 16, v188
    v_and_b32 v211, 0xffff0000, v188
    v_lshlrev_b32_e64 v212, 16, v132
    v_and_b32 v213, 0xffff0000, v132
    v_lshlrev_b32_e64 v214, 16, v189
    v_and_b32 v215, 0xffff0000, v189
    v_lshlrev_b32_e64 v216, 16, v133
    v_and_b32 v217, 0xffff0000, v133
    v_pk_mul_f32 v[210:211], v[210:211], v[212:213]
    v_pk_mul_f32 v[214:215], v[214:215], v[216:217]
    v_cvt_pk_bf16_f32 v212, v210, v211
    v_cvt_pk_bf16_f32 v216, v214, v215
    v_lshlrev_b32_e64 v210, 16, v212
    v_and_b32 v211, 0xffff0000, v212
    v_lshlrev_b32_e64 v214, 16, v216
    v_and_b32 v215, 0xffff0000, v216
    v_pk_add_f32 v[208:209], v[208:209], v[210:211]
    v_pk_add_f32 v[208:209], v[208:209], v[214:215]
    v_lshlrev_b32_e64 v210, 16, v190
    v_and_b32 v211, 0xffff0000, v190
    s_waitcnt lgkmcnt(3)
    v_lshlrev_b32 v212, 16, v134
    v_and_b32 v213, 0xffff0000, v134
    v_lshlrev_b32_e64 v214, 16, v191
    v_and_b32 v215, 0xffff0000, v191
    v_lshlrev_b32_e64 v216, 16, v135
    v_and_b32 v217, 0xffff0000, v135
    v_pk_mul_f32 v[210:211], v[210:211], v[212:213]
    v_pk_mul_f32 v[214:215], v[214:215], v[216:217]
    v_cvt_pk_bf16_f32 v212, v210, v211
    v_cvt_pk_bf16_f32 v216, v214, v215
    v_lshlrev_b32_e64 v210, 16, v212
    v_and_b32 v211, 0xffff0000, v212
    v_lshlrev_b32_e64 v214, 16, v216
    v_and_b32 v215, 0xffff0000, v216
    v_pk_add_f32 v[208:209], v[208:209], v[210:211]
    v_pk_add_f32 v[208:209], v[208:209], v[214:215]
    v_lshlrev_b32_e64 v210, 16, v192
    v_and_b32 v211, 0xffff0000, v192
    v_lshlrev_b32_e64 v212, 16, v136
    v_and_b32 v213, 0xffff0000, v136
    v_lshlrev_b32_e64 v214, 16, v193
    v_and_b32 v215, 0xffff0000, v193
    v_lshlrev_b32_e64 v216, 16, v137
    v_and_b32 v217, 0xffff0000, v137
    v_pk_mul_f32 v[210:211], v[210:211], v[212:213]
    v_pk_mul_f32 v[214:215], v[214:215], v[216:217]
    v_cvt_pk_bf16_f32 v212, v210, v211
    v_cvt_pk_bf16_f32 v216, v214, v215
    v_lshlrev_b32_e64 v210, 16, v212
    v_and_b32 v211, 0xffff0000, v212
    v_lshlrev_b32_e64 v214, 16, v216
    v_and_b32 v215, 0xffff0000, v216
    v_pk_add_f32 v[208:209], v[208:209], v[210:211]
    v_pk_add_f32 v[208:209], v[208:209], v[214:215]
    v_lshlrev_b32_e64 v210, 16, v194
    v_and_b32 v211, 0xffff0000, v194
    s_waitcnt lgkmcnt(2)
    v_lshlrev_b32 v212, 16, v138
    v_and_b32 v213, 0xffff0000, v138
    v_lshlrev_b32_e64 v214, 16, v195
    v_and_b32 v215, 0xffff0000, v195
    v_lshlrev_b32_e64 v216, 16, v139
    v_and_b32 v217, 0xffff0000, v139
    v_pk_mul_f32 v[210:211], v[210:211], v[212:213]
    v_pk_mul_f32 v[214:215], v[214:215], v[216:217]
    v_cvt_pk_bf16_f32 v212, v210, v211
    v_cvt_pk_bf16_f32 v216, v214, v215
    v_lshlrev_b32_e64 v210, 16, v212
    v_and_b32 v211, 0xffff0000, v212
    v_lshlrev_b32_e64 v214, 16, v216
    v_and_b32 v215, 0xffff0000, v216
    v_pk_add_f32 v[208:209], v[208:209], v[210:211]
    v_pk_add_f32 v[208:209], v[208:209], v[214:215]
    v_lshlrev_b32_e64 v210, 16, v196
    v_and_b32 v211, 0xffff0000, v196
    v_lshlrev_b32_e64 v212, 16, v140
    v_and_b32 v213, 0xffff0000, v140
    v_lshlrev_b32_e64 v214, 16, v197
    v_and_b32 v215, 0xffff0000, v197
    v_lshlrev_b32_e64 v216, 16, v141
    v_and_b32 v217, 0xffff0000, v141
    v_pk_mul_f32 v[210:211], v[210:211], v[212:213]
    v_pk_mul_f32 v[214:215], v[214:215], v[216:217]
    v_cvt_pk_bf16_f32 v212, v210, v211
    v_cvt_pk_bf16_f32 v216, v214, v215
    v_lshlrev_b32_e64 v210, 16, v212
    v_and_b32 v211, 0xffff0000, v212
    v_lshlrev_b32_e64 v214, 16, v216
    v_and_b32 v215, 0xffff0000, v216
    v_pk_add_f32 v[208:209], v[208:209], v[210:211]
    v_pk_add_f32 v[208:209], v[208:209], v[214:215]
    v_lshlrev_b32_e64 v210, 16, v198
    v_and_b32 v211, 0xffff0000, v198
    s_waitcnt lgkmcnt(1)
    v_lshlrev_b32 v212, 16, v142
    v_and_b32 v213, 0xffff0000, v142
    v_lshlrev_b32_e64 v214, 16, v199
    v_and_b32 v215, 0xffff0000, v199
    v_lshlrev_b32_e64 v216, 16, v143
    v_and_b32 v217, 0xffff0000, v143
    v_pk_mul_f32 v[210:211], v[210:211], v[212:213]
    v_pk_mul_f32 v[214:215], v[214:215], v[216:217]
    v_cvt_pk_bf16_f32 v212, v210, v211
    v_cvt_pk_bf16_f32 v216, v214, v215
    v_lshlrev_b32_e64 v210, 16, v212
    v_and_b32 v211, 0xffff0000, v212
    v_lshlrev_b32_e64 v214, 16, v216
    v_and_b32 v215, 0xffff0000, v216
    v_pk_add_f32 v[208:209], v[208:209], v[210:211]
    v_pk_add_f32 v[208:209], v[208:209], v[214:215]
    v_lshlrev_b32_e64 v210, 16, v200
    v_and_b32 v211, 0xffff0000, v200
    v_lshlrev_b32_e64 v212, 16, v144
    v_and_b32 v213, 0xffff0000, v144
    v_lshlrev_b32_e64 v214, 16, v201
    v_and_b32 v215, 0xffff0000, v201
    v_lshlrev_b32_e64 v216, 16, v145
    v_and_b32 v217, 0xffff0000, v145
    v_pk_mul_f32 v[210:211], v[210:211], v[212:213]
    v_pk_mul_f32 v[214:215], v[214:215], v[216:217]
    v_cvt_pk_bf16_f32 v212, v210, v211
    v_cvt_pk_bf16_f32 v216, v214, v215
    v_lshlrev_b32_e64 v210, 16, v212
    v_and_b32 v211, 0xffff0000, v212
    v_lshlrev_b32_e64 v214, 16, v216
    v_and_b32 v215, 0xffff0000, v216
    v_pk_add_f32 v[208:209], v[208:209], v[210:211]
    v_pk_add_f32 v[208:209], v[208:209], v[214:215]
    v_lshlrev_b32_e64 v210, 16, v202
    v_and_b32 v211, 0xffff0000, v202
    s_waitcnt lgkmcnt(0)
    v_lshlrev_b32 v212, 16, v146
    v_and_b32 v213, 0xffff0000, v146
    v_lshlrev_b32_e64 v214, 16, v203
    v_and_b32 v215, 0xffff0000, v203
    v_lshlrev_b32_e64 v216, 16, v147
    v_and_b32 v217, 0xffff0000, v147
    v_pk_mul_f32 v[210:211], v[210:211], v[212:213]
    v_pk_mul_f32 v[214:215], v[214:215], v[216:217]
    v_cvt_pk_bf16_f32 v212, v210, v211
    v_cvt_pk_bf16_f32 v216, v214, v215
    v_lshlrev_b32_e64 v210, 16, v212
    v_and_b32 v211, 0xffff0000, v212
    v_lshlrev_b32_e64 v214, 16, v216
    v_and_b32 v215, 0xffff0000, v216
    v_pk_add_f32 v[208:209], v[208:209], v[210:211]
    v_pk_add_f32 v[208:209], v[208:209], v[214:215]
    v_lshlrev_b32_e64 v210, 16, v204
    v_and_b32 v211, 0xffff0000, v204
    v_lshlrev_b32_e64 v212, 16, v148
    v_and_b32 v213, 0xffff0000, v148
    v_lshlrev_b32_e64 v214, 16, v205
    v_and_b32 v215, 0xffff0000, v205
    v_lshlrev_b32_e64 v216, 16, v149
    v_and_b32 v217, 0xffff0000, v149
    v_pk_mul_f32 v[210:211], v[210:211], v[212:213]
    v_pk_mul_f32 v[214:215], v[214:215], v[216:217]
    v_cvt_pk_bf16_f32 v212, v210, v211
    v_cvt_pk_bf16_f32 v216, v214, v215
    v_lshlrev_b32_e64 v210, 16, v212
    v_and_b32 v211, 0xffff0000, v212
    v_lshlrev_b32_e64 v214, 16, v216
    v_and_b32 v215, 0xffff0000, v216
    v_pk_add_f32 v[208:209], v[208:209], v[210:211]
    v_pk_add_f32 v[208:209], v[208:209], v[214:215]
    v_add_f32_e64 v208, v208, v209
    s_nop 1
    v_add_f32_dpp v208, v208, v208 quad_perm:[1,0,3,2] row_mask:0xf bank_mask:0xf
    s_nop 1
    v_add_f32_dpp v208, v208, v208 quad_perm:[2,3,0,1] row_mask:0xf bank_mask:0xf
    v_cvt_pk_bf16_f32 v10, v208, v208
    v_lshlrev_b32_e64 v10, 16, v10
    v_mul_f32 v10, 0xbfb8aa3b, v10
    v_exp_f32 v10, v10
    s_nop 0
    v_add_f32_e64 v10, 1.0, v10
    v_rcp_f32 v10, v10
    s_nop 0
    v_cvt_pk_bf16_f32 v10, v10, v10
    v_lshlrev_b32 v208, 16, v10
    v_sub_f32 v10, 1.0, v208
    v_cvt_pk_bf16_f32 v10, v10, v10
    v_lshlrev_b32 v209, 16, v10
    v_lshrrev_b32 v10, 2, v0
    v_lshlrev_b32 v10, 3, v10
    s_lshl_b32 s3, s94, 9
    s_add_u32 s3, s3, 12582912
    s_mov_b32 exec_lo, 0x11111111
    s_mov_b32 exec_hi, 0x11111111
    buffer_store_dwordx2 v[208:209], v10, s[52:55], s3 offen sc1
    s_mov_b64 exec, -1
    s_waitcnt vmcnt(0)
    s_barrier
    s_cmp_eq_u32 s60, 0
    s_cbranch_scc0 L_h2
    s_mov_b64 exec, 0xff
    buffer_store_dwordx4 v[26:29], v21, s[52:55], 0 offen sc1
    s_mov_b64 exec, -1
L_h2:
    s_endpgm
L_end:
    s_endpgm
.section .rodata,"a"
.p2align 6
.amdhsa_kernel gated_mix__ssm_conv_s4__geglu_ffn__prompt_kernel
  .amdhsa_next_free_vgpr 512
  .amdhsa_next_free_sgpr 102
  .amdhsa_accum_offset 256
  .amdhsa_group_segment_fixed_size 0
  .amdhsa_kernarg_size 136
  .amdhsa_user_sgpr_count 2
  .amdhsa_user_sgpr_kernarg_segment_ptr 1
  .amdhsa_system_sgpr_workgroup_id_x 1
  .amdhsa_float_denorm_mode_32 3
.end_amdhsa_kernel
```
